```python
import torch

def _softmax(x, axis=-1):
    return torch.softmax(x, dim=axis)

def _gelu(x):
    return torch.nn.functional.gelu(x, approximate='tanh')

def _silu(x):
    return torch.nn.functional.silu(x)

def _sigmoid(x):
    return torch.sigmoid(x)

def _layernorm(x, axis=-1, eps=1e-05):
    m = x.mean(dim=axis, keepdim=True)
    v = x.var(dim=axis, keepdim=True, unbiased=False)
    return (x - m) / torch.sqrt(v + eps)

def _scatter_add(tgt, idx, src, axis=0):
    return tgt.clone().index_add_(axis, idx, src)

def _segment_sum(src, seg, n):
    out = torch.zeros((n,) + src.shape[1:], dtype=src.dtype)
    return out.index_add_(0, seg, src)

def _pad(x, pw):
    flat = tuple((v for pair in reversed(pw) for v in pair))
    return torch.nn.functional.pad(x, flat)
kernel_name = 'adaLN_cond__ssm_conv_h3__mixer_gmlp__prompt'

def setup_inputs():

    _w = lambda a: (lambda t: t.to(torch.bfloat16) if t.is_floating_point() else t)(torch.as_tensor(a))

    def _A_setup():
        B, S, D = (1, 2048, 512)
        ks = 4
        return {'q': _w((lambda *s: torch.randn(*s, dtype=torch.bfloat16) * 0.05)(B, S, D)), 'k': _w((lambda *s: torch.randn(*s, dtype=torch.bfloat16) * 0.8)(B, S, D)), 'v': _w((lambda *s: torch.randn(*s, dtype=torch.bfloat16) * 0.4)(B, S, D)), 'shift_k': _w((lambda *s: torch.randn(*s, dtype=torch.bfloat16) * 0.8)(D, ks) * 0.5), 'ssm_k': _w((lambda *s: torch.randn(*s, dtype=torch.bfloat16) * 0.8)(D, S) * (1.0 / S ** 0.5)), 'ssm_D': _w((lambda *s: torch.randn(*s, dtype=torch.bfloat16) * 0.4)(D))}
    _A_in = _A_setup()

    def _B_setup():
        B, S, D, F = (1, 2048, 512, 1792)
        Fh = F // 2
        return {'x': _w((lambda *s: torch.randn(*s, dtype=torch.bfloat16) * 0.05)(B, S, D)), 'w_in': _w((lambda *s: torch.randn(*s, dtype=torch.bfloat16) * 0.4)(D, 2 * Fh)), 'w_sp': _w(0.01 * (lambda *s: torch.randn(*s, dtype=torch.bfloat16) * 0.4)(S, S)), 'b_sp': _w(1.0 + 0.01 * (lambda *s: torch.randn(*s, dtype=torch.bfloat16) * 0.05)(S)), 'w_out': _w((lambda *s: torch.randn(*s, dtype=torch.bfloat16) * 0.05)(Fh, D))}
    _B_in = _B_setup()
    return {'A_q': _A_in['q'], 'A_k': _A_in['k'], 'A_v': _A_in['v'], 'A_shift_k': _A_in['shift_k'], 'A_ssm_k': _A_in['ssm_k'], 'A_ssm_D': _A_in['ssm_D'], 'B_x': _B_in['x'], 'B_w_in': _B_in['w_in'], 'B_w_sp': _B_in['w_sp'], 'B_b_sp': _B_in['b_sp'], 'B_w_out': _B_in['w_out'], 'c': _w((lambda *s: torch.randn(*s, dtype=torch.bfloat16) * 0.1)(1, 512) * 8.0), 'w_mod': _w((lambda *s: torch.randn(*s, dtype=torch.bfloat16) * 0.1)(512, 6 * 512) * 512 ** (-0.5) * 8.0)}

def reference(A_q, A_k, A_v, A_shift_k, A_ssm_k, A_ssm_D, B_x, B_w_in, B_w_sp, B_b_sp, B_w_out, c, w_mod):

    def _A_ref(q, k, v, shift_k, ssm_k, ssm_D):
        B, S, D = q.shape
        ks = shift_k.shape[-1]
        k_pad = _pad(k, ((0, 0), (ks - 1, 0), (0, 0)))
        k_shift = torch.zeros_like(k)
        for t in range(ks):
            k_shift = k_shift + k_pad[:, t:t + S, :] * shift_k[:, ks - 1 - t][None, None, :]
        kv = k_shift * v
        L = 2 * S
        kv_pad = _pad(kv, ((0, 0), (0, S), (0, 0)))
        kf_pad = _pad(ssm_k, ((0, 0), (0, S)))
        kv_f = (lambda x, axes=(-2, -1): torch.fft.rfft2(x.float(), dim=axes))(kv_pad[:, None, :, :], axes=(1, 2))
        kf_f = (lambda x, axes=(-2, -1): torch.fft.rfft2(x.float(), dim=axes))(kf_pad[:, None, :], axes=(1, 2))
        kf_f = (lambda x, *d: x.permute(*d))(kf_f, 1, 2, 0)
        y_f = kv_f * kf_f[None, :, :, :]
        y = (lambda x, s, axes=(-2, -1): torch.fft.irfft2(x, s=s, dim=axes).to(torch.bfloat16))(y_f, (1, L), axes=(1, 2))[:, 0, :S, :]
        y = y + kv * ssm_D[None, None, :]
        return q * y

    def _B_ref(x, w_in, w_sp, b_sp, w_out):
        B, S, D = x.shape
        F = w_in.shape[-1]
        Fh = F // 2
        z = _gelu(torch.einsum('bsd,df->bsf', x, w_in))
        z1 = z[..., :Fh].clone()
        z2 = _layernorm(z[..., Fh:], axis=-1)
        g = torch.einsum('ts,bsf->btf', w_sp, z2) + b_sp[None, :, None]
        return torch.einsum('bsf,fd->bsd', z1 * g, w_out)
    x = A_q
    mod = (_silu(c) @ w_mod).reshape(c.shape[0], 6, 1, -1)
    sa, ca, ga, sb, cb, gb = (mod[:, 0].clone(), mod[:, 1].clone(), mod[:, 2].clone(), mod[:, 3].clone(), mod[:, 4].clone(), mod[:, 5].clone())
    h = _layernorm(x, axis=-1) * (1 + ca) + sa
    x = x + ga * _A_ref(h, A_k, A_v, A_shift_k, A_ssm_k, A_ssm_D)
    h = _layernorm(x, axis=-1) * (1 + cb) + sb
    x = x + gb * _B_ref(h, B_w_in, B_w_sp, B_b_sp, B_w_out)
    return x
```

```asm
; @launch grid=(256,1,1) block=(256,1,1) lds=158720
.amdgcn_target "amdgcn-amd-amdhsa--gfx950"
.text
.globl adaLN_cond__ssm_conv_h3__mixer_gmlp__prompt_kernel
.p2align 8
.type adaLN_cond__ssm_conv_h3__mixer_gmlp__prompt_kernel,@function
adaLN_cond__ssm_conv_h3__mixer_gmlp__prompt_kernel:
  s_getpc_b64 s[96:97]
  s_cmp_ge_u32 s2, 256
  s_cbranch_scc1 L_exit
  v_lshlrev_b32 v6, 4, v0
  s_load_dwordx2 s[60:61], s[0:1], 120
  s_load_dwordx2 s[8:9], s[0:1], 8
  s_load_dwordx2 s[12:13], s[0:1], 16
  s_load_dwordx2 s[20:21], s[0:1], 32
  s_load_dwordx2 s[16:17], s[0:1], 24
  s_load_dwordx2 s[44:45], s[0:1], 88
  s_load_dwordx2 s[56:57], s[0:1], 112
  global_load_dwordx4 v[240:243], v6, s[96:97]
  v_add_u32 v7, 0x1000, v6
  global_load_dwordx4 v[244:247], v7, s[96:97]
  v_lshrrev_b32 v5, 6, v0
  v_and_b32 v1, 63, v0
  s_and_b32 s64, s2, 7
  v_readfirstlane_b32 s66, v5
  s_lshr_b32 s65, s2, 3
  v_lshrrev_b32 v16, 3, v1
  v_and_b32 v17, 7, v0
  v_lshlrev_b32 v17, 4, v17
  v_lshl_add_u32 v17, v16, 10, v17
  s_lshl_b32 s70, s65, 16
  s_lshl_b32 s71, s64, 7
  s_add_u32 s70, s70, s71
  v_add_u32 v17, s70, v17
  v_mov_b32 v29, 0
  v_mov_b32 v100, 0
  v_mov_b32 v101, 0
  s_mov_b32 s62, 0x1100000
  s_mov_b32 s63, 0x20000
  s_cmp_ge_u32 s66, 2
  s_cbranch_scc1 L_ini23
  s_lshl_b32 s71, s66, 15
  v_add_u32 v19, s71, v17
  v_subrev_u32 v18, 0x2000, v19
  s_mul_i32 s72, s66, 9216
  s_add_u32 s72, s72, 52480
  s_mov_b32 m0, s72
  s_mov_b32 s10, 0x200000
  s_mov_b32 s11, 0x20000
  s_mov_b32 s14, 0x200000
  s_mov_b32 s15, 0x20000
  s_mov_b32 s73, 0
  s_waitcnt lgkmcnt(0)
  buffer_load_dwordx4 v18, s[8:11], 0 offen nt lds
  s_add_u32 m0, m0, 1024
  s_nop 0
  buffer_load_dwordx4 v19, s[8:11], s73 offen nt lds
  s_add_u32 m0, m0, 4096
  s_nop 0
  buffer_load_dwordx4 v19, s[12:15], s73 offen nt lds
  s_sub_u32 m0, m0, 4096
  s_add_u32 s73, s73, 8192
  s_add_u32 m0, m0, 1024
  s_nop 0
  buffer_load_dwordx4 v19, s[8:11], s73 offen nt lds
  s_add_u32 m0, m0, 4096
  s_nop 0
  buffer_load_dwordx4 v19, s[12:15], s73 offen nt lds
  s_sub_u32 m0, m0, 4096
  s_add_u32 s73, s73, 8192
  s_add_u32 m0, m0, 1024
  s_nop 0
  buffer_load_dwordx4 v19, s[8:11], s73 offen nt lds
  s_add_u32 m0, m0, 4096
  s_nop 0
  buffer_load_dwordx4 v19, s[12:15], s73 offen nt lds
  s_sub_u32 m0, m0, 4096
  s_add_u32 s73, s73, 8192
  s_add_u32 m0, m0, 1024
  s_nop 0
  buffer_load_dwordx4 v19, s[8:11], s73 offen nt lds
  s_add_u32 m0, m0, 4096
  s_nop 0
  buffer_load_dwordx4 v19, s[12:15], s73 offen nt lds
  s_sub_u32 m0, m0, 4096
  s_add_u32 s73, s73, 8192
  s_mov_b32 s18, 4096
  s_mov_b32 s19, 0x20000
  s_lshl_b32 s70, s64, 9
  v_lshl_add_u32 v21, v1, 3, s70
  buffer_load_dwordx2 v[26:27], v21, s[16:19], 0 offen
  s_branch L_ini
L_ini23:
  s_lshl_b32 s70, s64, 18
  s_lshl_b32 s71, s65, 13
  s_add_u32 s70, s70, s71
  v_subrev_u32 v20, 2048, v6
  v_add_u32 v24, s70, v20
  v_subrev_u32 v25, 8, v24
  v_add_u32 v23, 2040, v24
  s_mov_b32 s22, 0x200000
  s_mov_b32 s23, 0x20000
  s_mov_b32 s74, 4096
  v_lshlrev_b32 v4, 4, v1
  s_lshl_b32 s72, s66, 8
  s_add_u32 s72, s72, s2
  s_cmp_eq_u32 s72, 767
  s_waitcnt lgkmcnt(0)
  s_cbranch_scc0 L_nozero
  v_lshlrev_b32 v22, 9, v1
  buffer_store_dword v29, v22, s[60:63], 0 offen sc1
  buffer_store_dword v29, v22, s[60:63], 0 offen offset:256 sc1
  buffer_store_dword v29, v22, s[60:63], 0 offen offset:128 sc1
  buffer_store_dword v29, v22, s[60:63], 0 offen offset:384 sc1
  s_mov_b32 s58, 256
  s_mov_b32 s59, 0x20000
  v_mov_b32 v22, 1
  s_waitcnt vmcnt(0)
  s_mov_b64 exec, 1
  buffer_store_dword v22, v29, s[56:59], 0 offen sc1
  s_mov_b64 exec, -1
L_nozero:
  buffer_load_dwordx4 v[106:109], v24, s[20:23], 0 offen offset:0 nt
  buffer_load_dwordx2 v[104:105], v25, s[20:23], 0 offen nt
  buffer_load_dwordx4 v[114:117], v24, s[20:23], 0 offen offset:2048 nt
  buffer_load_dwordx2 v[112:113], v23, s[20:23], 0 offen nt
  buffer_load_dwordx4 v[122:125], v24, s[20:23], s74 offen offset:0 nt
  buffer_load_dwordx2 v[120:121], v25, s[20:23], s74 offen nt
  buffer_load_dwordx4 v[130:133], v24, s[20:23], s74 offen offset:2048 nt
  buffer_load_dwordx2 v[128:129], v23, s[20:23], s74 offen nt
  s_mov_b32 s46, 1024
  s_mov_b32 s47, 0x20000
  s_and_b32 s71, s2, 3
  s_lshl_b32 s70, s71, 8
  v_lshl_add_u32 v22, v1, 2, s70
  buffer_load_dword v232, v22, s[44:47], 0 offen
L_ini:
  s_mov_b32 s58, 256
  s_mov_b32 s59, 0x20000
  s_load_dwordx2 s[4:5], s[0:1], 0
  s_load_dwordx2 s[48:49], s[0:1], 96
  s_load_dwordx2 s[24:25], s[0:1], 40
  s_load_dwordx2 s[28:29], s[0:1], 56
  s_load_dwordx2 s[32:33], s[0:1], 64
  s_load_dwordx2 s[36:37], s[0:1], 72
  s_load_dwordx2 s[40:41], s[0:1], 80
  s_load_dwordx2 s[52:53], s[0:1], 104
  s_and_b32 s3, s65, 7
  s_lshl_b32 s3, s3, 12
  v_add_u32 v7, s3, v6
  v_add_u32 v7, 0x1000, v7
  v_min_u32 v7, (L_exit-adaLN_cond__ssm_conv_h3__mixer_gmlp__prompt_kernel-4200), v7
  global_load_dwordx4 v[252:255], v7, s[96:97] offset:4080
  s_mov_b32 s6, 0x200000
  s_mov_b32 s7, 0x20000
  s_mov_b32 s50, 0x300000
  s_mov_b32 s51, 0x20000
  s_mov_b32 s26, 0x400
  s_mov_b32 s27, 0x20000
  s_mov_b32 s30, 0x1c0000
  s_mov_b32 s31, 0x20000
  s_mov_b32 s34, 0x800000
  s_mov_b32 s35, 0x20000
  s_mov_b32 s38, 0x1000
  s_mov_b32 s39, 0x20000
  s_mov_b32 s42, 0xe0000
  s_mov_b32 s43, 0x20000
  s_mov_b32 s54, 0x200000
  s_mov_b32 s55, 0x20000
  v_lshlrev_b32 v4, 4, v1
  v_and_b32 v2, 15, v0
  v_bfe_u32 v3, v0, 4, 2
  s_mov_b32 s69, 0xffff0000
  s_lshl_b32 s76, s64, 6
  s_lshl_b32 s70, s65, 1
  s_add_u32 s76, s76, s70
  s_lshr_b32 s67, s64, 1
  s_lshl_b32 s67, s67, 3
  s_lshr_b32 s70, s65, 2
  s_add_u32 s67, s67, s70
  s_and_b32 s68, s64, 1
  s_lshl_b32 s68, s68, 2
  s_and_b32 s70, s65, 3
  s_add_u32 s68, s68, s70
  v_lshrrev_b32 v21, 2, v2
  v_lshlrev_b32 v21, 7, v21
  v_lshl_add_u32 v21, v3, 5, v21
  v_and_b32 v22, 3, v2
  v_lshl_add_u32 v21, v22, 3, v21
  v_lshrrev_b32 v37, 2, v2
  v_lshl_add_u32 v37, v3, 3, v37
  v_lshlrev_b32 v37, 5, v37
  v_lshl_add_u32 v5, v22, 3, v37
  s_lshl_b32 s87, s65, 2
  s_add_u32 s87, s87, s66
  s_lshl_b32 s70, s65, 7
  s_mul_i32 s71, s64, 229376
  s_add_u32 s70, s70, s71
  s_cmp_lt_u32 s65, 28
  s_cselect_b32 s71, 0, 0x80000000
  s_add_u32 s70, s70, s71
  v_mul_u32_u24 v14, 3584, v16
  v_and_b32 v32, 7, v1
  v_bfe_u32 v33, v1, 4, 1
  v_lshlrev_b32 v33, 1, v33
  v_xor_b32 v32, v32, v33
  v_lshl_add_u32 v14, v32, 4, v14
  v_add_u32 v14, s70, v14
  v_lshrrev_b32 v32, 1, v1
  v_and_b32 v33, 1, v1
  v_lshlrev_b32 v33, 4, v33
  v_lshl_add_u32 v31, v32, 10, v33
  s_waitcnt lgkmcnt(0)
  s_cmp_ge_u32 s66, 2
  s_cbranch_scc1 L_p0_23
  v_add_u32 v22, s72, v21
  s_lshl_b32 s70, s65, 3
  s_lshl_b32 s71, s66, 2
  s_add_u32 s70, s70, s71
  s_sub_u32 s70, 252, s70
  s_lshl_b32 s70, s70, 10
  s_lshl_b32 s71, s64, 18
  s_add_u32 s70, s70, s71
  s_add_u32 s70, s70, 1048576
  s_and_b32 s71, s65, 1
  s_xor_b32 s71, s71, 1
  s_lshl_b32 s71, s71, 4
  v_xor_b32 v23, s71, v4
  v_add_u32 v23, s70, v23
  s_waitcnt lgkmcnt(0)
  s_waitcnt vmcnt(1)
  ds_read_b64_tr_b16 v[32:33], v22 offset:512
  ds_read_b64_tr_b16 v[34:35], v22 offset:1024
  ds_read_b64_tr_b16 v[36:37], v22 offset:1536
  ds_read_b64_tr_b16 v[38:39], v22 offset:2048
  ds_read_b64_tr_b16 v[40:41], v22 offset:2560
  ds_read_b64_tr_b16 v[42:43], v22 offset:3072
  ds_read_b64_tr_b16 v[44:45], v22 offset:3584
  ds_read_b64_tr_b16 v[46:47], v22 offset:4096
  ds_read_b64_tr_b16 v[48:49], v22 offset:4608
  v_alignbit_b32 v26, v26, v26, 16
  v_alignbit_b32 v27, v27, v27, 16
  s_mov_b64 exec, 1
  buffer_load_dword v30, v29, s[56:59], 0 offen sc1
  s_mov_b64 exec, -1
  ds_read_b64_tr_b16 v[68:69], v22 offset:5120
  ds_read_b64_tr_b16 v[70:71], v22 offset:5632
  ds_read_b64_tr_b16 v[72:73], v22 offset:6144
  ds_read_b64_tr_b16 v[74:75], v22 offset:6656
  ds_read_b64_tr_b16 v[76:77], v22 offset:7168
  ds_read_b64_tr_b16 v[78:79], v22 offset:7680
  ds_read_b64_tr_b16 v[80:81], v22 offset:8192
  ds_read_b64_tr_b16 v[82:83], v22 offset:8704
  s_waitcnt lgkmcnt(14)
  v_alignbit_b32 v51, v33, v32, 16
  v_alignbit_b32 v52, v34, v33, 16
  v_alignbit_b32 v53, v35, v34, 16
  v_alignbit_b32 v54, v36, v35, 16
  v_alignbit_b32 v55, v37, v36, 16
  v_dot2_f32_bf16 v129, v33, v27, 0
  v_dot2_f32_bf16 v128, v51, v27, 0
  v_dot2_f32_bf16 v131, v34, v27, 0
  v_dot2_f32_bf16 v130, v52, v27, 0
  v_dot2_f32_bf16 v133, v35, v27, 0
  v_dot2_f32_bf16 v132, v53, v27, 0
  v_dot2_f32_bf16 v135, v36, v27, 0
  v_dot2_f32_bf16 v134, v54, v27, 0
  v_dot2c_f32_bf16 v129, v34, v26
  v_dot2c_f32_bf16 v128, v52, v26
  v_dot2c_f32_bf16 v131, v35, v26
  v_dot2c_f32_bf16 v130, v53, v26
  v_dot2c_f32_bf16 v133, v36, v26
  v_dot2c_f32_bf16 v132, v54, v26
  v_dot2c_f32_bf16 v135, v37, v26
  v_dot2c_f32_bf16 v134, v55, v26
  s_waitcnt lgkmcnt(6)
  v_lshlrev_b32 v160, 16, v68
  v_and_b32 v161, s69, v68
  v_lshlrev_b32 v162, 16, v69
  v_and_b32 v163, s69, v69
  v_lshlrev_b32 v164, 16, v70
  v_and_b32 v165, s69, v70
  v_lshlrev_b32 v166, 16, v71
  v_and_b32 v167, s69, v71
  v_pk_mul_f32 v[128:129], v[128:129], v[160:161]
  v_pk_mul_f32 v[130:131], v[130:131], v[162:163]
  v_pk_mul_f32 v[132:133], v[132:133], v[164:165]
  v_pk_mul_f32 v[134:135], v[134:135], v[166:167]
  v_cvt_pk_bf16_f32 v192, v135, v134
  v_cvt_pk_bf16_f32 v193, v133, v132
  v_cvt_pk_bf16_f32 v194, v131, v130
  v_cvt_pk_bf16_f32 v195, v129, v128
  buffer_store_dwordx4 v[192:195], v23, s[60:63], 0 offen offset:3072 sc1
  v_alignbit_b32 v56, v38, v37, 16
  v_alignbit_b32 v57, v39, v38, 16
  v_alignbit_b32 v58, v40, v39, 16
  v_alignbit_b32 v59, v41, v40, 16
  v_dot2_f32_bf16 v137, v37, v27, 0
  v_dot2_f32_bf16 v136, v55, v27, 0
  v_dot2_f32_bf16 v139, v38, v27, 0
  v_dot2_f32_bf16 v138, v56, v27, 0
  v_dot2_f32_bf16 v141, v39, v27, 0
  v_dot2_f32_bf16 v140, v57, v27, 0
  v_dot2_f32_bf16 v143, v40, v27, 0
  v_dot2_f32_bf16 v142, v58, v27, 0
  v_dot2c_f32_bf16 v137, v38, v26
  v_dot2c_f32_bf16 v136, v56, v26
  v_dot2c_f32_bf16 v139, v39, v26
  v_dot2c_f32_bf16 v138, v57, v26
  v_dot2c_f32_bf16 v141, v40, v26
  v_dot2c_f32_bf16 v140, v58, v26
  v_dot2c_f32_bf16 v143, v41, v26
  v_dot2c_f32_bf16 v142, v59, v26
  s_waitcnt lgkmcnt(4)
  v_lshlrev_b32 v168, 16, v72
  v_and_b32 v169, s69, v72
  v_lshlrev_b32 v170, 16, v73
  v_and_b32 v171, s69, v73
  v_lshlrev_b32 v172, 16, v74
  v_and_b32 v173, s69, v74
  v_lshlrev_b32 v174, 16, v75
  v_and_b32 v175, s69, v75
  v_pk_mul_f32 v[136:137], v[136:137], v[168:169]
  v_pk_mul_f32 v[138:139], v[138:139], v[170:171]
  v_pk_mul_f32 v[140:141], v[140:141], v[172:173]
  v_pk_mul_f32 v[142:143], v[142:143], v[174:175]
  v_cvt_pk_bf16_f32 v196, v143, v142
  v_cvt_pk_bf16_f32 v197, v141, v140
  v_cvt_pk_bf16_f32 v198, v139, v138
  v_cvt_pk_bf16_f32 v199, v137, v136
  buffer_store_dwordx4 v[196:199], v23, s[60:63], 0 offen offset:2048 sc1
  v_alignbit_b32 v60, v42, v41, 16
  v_alignbit_b32 v61, v43, v42, 16
  v_alignbit_b32 v62, v44, v43, 16
  v_alignbit_b32 v63, v45, v44, 16
  v_dot2_f32_bf16 v145, v41, v27, 0
  v_dot2_f32_bf16 v144, v59, v27, 0
  v_dot2_f32_bf16 v147, v42, v27, 0
  v_dot2_f32_bf16 v146, v60, v27, 0
  v_dot2_f32_bf16 v149, v43, v27, 0
  v_dot2_f32_bf16 v148, v61, v27, 0
  v_dot2_f32_bf16 v151, v44, v27, 0
  v_dot2_f32_bf16 v150, v62, v27, 0
  v_dot2c_f32_bf16 v145, v42, v26
  v_dot2c_f32_bf16 v144, v60, v26
  v_dot2c_f32_bf16 v147, v43, v26
  v_dot2c_f32_bf16 v146, v61, v26
  v_dot2c_f32_bf16 v149, v44, v26
  v_dot2c_f32_bf16 v148, v62, v26
  v_dot2c_f32_bf16 v151, v45, v26
  v_dot2c_f32_bf16 v150, v63, v26
  s_waitcnt lgkmcnt(2)
  v_lshlrev_b32 v176, 16, v76
  v_and_b32 v177, s69, v76
  v_lshlrev_b32 v178, 16, v77
  v_and_b32 v179, s69, v77
  v_lshlrev_b32 v180, 16, v78
  v_and_b32 v181, s69, v78
  v_lshlrev_b32 v182, 16, v79
  v_and_b32 v183, s69, v79
  v_pk_mul_f32 v[144:145], v[144:145], v[176:177]
  v_pk_mul_f32 v[146:147], v[146:147], v[178:179]
  v_pk_mul_f32 v[148:149], v[148:149], v[180:181]
  v_pk_mul_f32 v[150:151], v[150:151], v[182:183]
  v_cvt_pk_bf16_f32 v200, v151, v150
  v_cvt_pk_bf16_f32 v201, v149, v148
  v_cvt_pk_bf16_f32 v202, v147, v146
  v_cvt_pk_bf16_f32 v203, v145, v144
  buffer_store_dwordx4 v[200:203], v23, s[60:63], 0 offen offset:1024 sc1
  v_alignbit_b32 v64, v46, v45, 16
  v_alignbit_b32 v65, v47, v46, 16
  v_alignbit_b32 v66, v48, v47, 16
  v_alignbit_b32 v67, v49, v48, 16
  v_dot2_f32_bf16 v153, v45, v27, 0
  v_dot2_f32_bf16 v152, v63, v27, 0
  v_dot2_f32_bf16 v155, v46, v27, 0
  v_dot2_f32_bf16 v154, v64, v27, 0
  v_dot2_f32_bf16 v157, v47, v27, 0
  v_dot2_f32_bf16 v156, v65, v27, 0
  v_dot2_f32_bf16 v159, v48, v27, 0
  v_dot2_f32_bf16 v158, v66, v27, 0
  v_dot2c_f32_bf16 v153, v46, v26
  v_dot2c_f32_bf16 v152, v64, v26
  v_dot2c_f32_bf16 v155, v47, v26
  v_dot2c_f32_bf16 v154, v65, v26
  v_dot2c_f32_bf16 v157, v48, v26
  v_dot2c_f32_bf16 v156, v66, v26
  v_dot2c_f32_bf16 v159, v49, v26
  v_dot2c_f32_bf16 v158, v67, v26
  s_waitcnt lgkmcnt(0)
  v_lshlrev_b32 v184, 16, v80
  v_and_b32 v185, s69, v80
  v_lshlrev_b32 v186, 16, v81
  v_and_b32 v187, s69, v81
  v_lshlrev_b32 v188, 16, v82
  v_and_b32 v189, s69, v82
  v_lshlrev_b32 v190, 16, v83
  v_and_b32 v191, s69, v83
  v_pk_mul_f32 v[152:153], v[152:153], v[184:185]
  v_pk_mul_f32 v[154:155], v[154:155], v[186:187]
  v_pk_mul_f32 v[156:157], v[156:157], v[188:189]
  v_pk_mul_f32 v[158:159], v[158:159], v[190:191]
  v_cvt_pk_bf16_f32 v204, v159, v158
  v_cvt_pk_bf16_f32 v205, v157, v156
  v_cvt_pk_bf16_f32 v206, v155, v154
  v_cvt_pk_bf16_f32 v207, v153, v152
  buffer_store_dwordx4 v[204:207], v23, s[60:63], 0 offen offset:0 sc1
  s_waitcnt vmcnt(0)
  s_barrier
  s_cmp_eq_u32 s66, 0
  s_cbranch_scc0 L_ow_1
  v_readfirstlane_b32 s70, v30
  s_nop 0
  s_cmp_lg_u32 s70, 0
  s_cbranch_scc1 L_fl_2
  v_mov_b32 v37, 0
  s_mov_b32 s77, 0
  s_mov_b64 exec, 0x1
L_poll_3:
  buffer_load_dword v30, v37, s[56:59], 0 offen  sc1
  s_waitcnt vmcnt(0)
  v_cmp_gt_u32 vcc, 1, v30
  s_nop 0
  s_cbranch_vccz L_polld_4
  s_sleep 1
  s_add_u32 s77, s77, 1
  s_cmp_lt_u32 s77, 200000
  s_cbranch_scc1 L_poll_3
L_polld_4:
  s_mov_b64 exec, -1
L_fl_2:
  s_and_b32 s70, s2, 15
  s_lshl_b32 s70, s70, 8
  s_add_u32 s70, s70, 0
  v_mov_b32 v37, s70
  v_mov_b32 v38, 1
  s_mov_b64 exec, 1
  buffer_atomic_add v38, v37, s[60:63], 0 offen sc1
  s_mov_b64 exec, -1
L_ow_1:
  s_cmp_eq_u32 s66, 1
  s_cbranch_scc0 L_ow_6
  v_xor_b32 v37, 64, v14
  s_mov_b32 m0, 147456
  s_mov_b32 s73, 0
  buffer_load_dwordx4 v14, s[28:31], s73 offen nt lds
  s_mov_b32 m0, 148480
  s_mov_b32 s73, 28672
  buffer_load_dwordx4 v37, s[28:31], s73 offen nt lds
  s_mov_b32 m0, 149504
  s_mov_b32 s73, 57344
  buffer_load_dwordx4 v14, s[28:31], s73 offen nt lds
  s_mov_b32 m0, 150528
  s_mov_b32 s73, 86016
  buffer_load_dwordx4 v37, s[28:31], s73 offen nt lds
  s_mov_b32 m0, 151552
  s_mov_b32 s73, 114688
  buffer_load_dwordx4 v14, s[28:31], s73 offen nt lds
  s_mov_b32 m0, 152576
  s_mov_b32 s73, 143360
  buffer_load_dwordx4 v37, s[28:31], s73 offen nt lds
  s_mov_b32 m0, 153600
  s_mov_b32 s73, 172032
  buffer_load_dwordx4 v14, s[28:31], s73 offen nt lds
  s_mov_b32 m0, 154624
  s_mov_b32 s73, 200704
  buffer_load_dwordx4 v37, s[28:31], s73 offen nt lds
L_ow_6:
  v_and_b32 v32, 7, v1
  v_xor_b32 v32, v16, v32
  v_lshlrev_b32 v32, 4, v32
  v_lshl_add_u32 v32, v16, 12, v32
  s_lshl_b32 s70, s67, 18
  s_lshl_b32 s71, s66, 10
  s_add_u32 s70, s70, s71
  v_add_u32 v8, s70, v32
  s_lshl_b32 s84, s66, 14
  s_add_u32 s84, s84, 81920
  s_and_b32 s85, s68, 3
  s_lshl_b32 s85, s85, 8
  v_and_b32 v32, 7, v2
  v_xor_b32 v32, v32, v3
  v_lshlrev_b32 v32, 4, v32
  v_lshl_add_u32 v32, v2, 7, v32
  v_add_u32 v10, s84, v32
  v_xor_b32 v11, 64, v10
  s_add_u32 s80, s66, 0
  s_and_b32 s80, s80, 3
  s_lshl_b32 s80, s80, 16
  s_add_u32 s81, s66, 1
  s_and_b32 s81, s81, 3
  s_lshl_b32 s81, s81, 16
  s_add_u32 s82, s66, 2
  s_and_b32 s82, s82, 3
  s_lshl_b32 s82, s82, 16
  s_add_u32 s83, s66, 3
  s_and_b32 s83, s83, 3
  s_lshl_b32 s83, s83, 16
  s_lshr_b32 s70, s66, 1
  s_add_u32 s78, s76, s70
  s_and_b32 s79, s66, 1
  s_mul_i32 s71, s70, 16640
  s_lshl_b32 s72, s79, 8
  s_add_u32 s71, s71, s72
  s_add_u32 s71, s71, 8
  v_and_b32 v25, 3, v2
  v_mul_u32_u24 v25, 4160, v25
  v_lshrrev_b32 v26, 2, v2
  v_lshl_add_u32 v25, v26, 3, v25
  v_lshl_add_u32 v25, v3, 4, v25
  v_add_u32 v13, s71, v25
  s_lshl_b32 s72, s79, 4
  s_add_u32 s72, s72, 30
  v_lshlrev_b32 v25, 1, v2
  v_sub_u32 v25, v3, v25
  v_add_u32 v25, s72, v25
  v_add_u32 v26, 0, v25
  v_bfe_u32 v27, v26, 3, 1
  v_xor_b32 v27, s70, v27
  v_lshlrev_b32 v26, 5, v26
  v_lshl_add_u32 v16, v27, 4, v26
  v_add_u32 v26, 4, v25
  v_bfe_u32 v27, v26, 3, 1
  v_xor_b32 v27, s70, v27
  v_lshlrev_b32 v26, 5, v26
  v_lshl_add_u32 v17, v27, 4, v26
  v_add_u32 v26, 8, v25
  v_bfe_u32 v27, v26, 3, 1
  v_xor_b32 v27, s70, v27
  v_lshlrev_b32 v26, 5, v26
  v_lshl_add_u32 v18, v27, 4, v26
  v_add_u32 v26, 12, v25
  v_bfe_u32 v27, v26, 3, 1
  v_xor_b32 v27, s70, v27
  v_lshlrev_b32 v26, 5, v26
  v_lshl_add_u32 v19, v27, 4, v26
  s_lshl_b32 s72, s64, 8
  s_add_u32 s72, s72, 530432
  v_lshl_add_u32 v20, v1, 2, s72
  s_mul_i32 s72, s66, 384
  s_add_u32 s72, s72, 72960
  v_lshl_add_u32 v21, v1, 2, s72
  v_lshl_add_u32 v15, v1, 1, s72
  v_lshl_add_u32 v28, v3, 5, s72
  v_lshl_add_u32 v29, v3, 4, s72
  s_lshl_b32 s71, s66, 12
  s_add_u32 s71, s71, 217088
  v_add_u32 v22, s71, v4
  s_lshl_b32 s71, s78, 2
  s_add_u32 s71, s71, 524288
  v_and_b32 v23, 3, v1
  v_mul_u32_u24 v23, 12288, v23
  v_bfe_u32 v7, v1, 2, 2
  v_lshl_add_u32 v23, v7, 11, v23
  v_add_u32 v23, s71, v23
  s_lshl_b32 s71, s78, 1
  v_mov_b32 v24, s71
  s_lshl_b32 s71, s64, 18
  s_lshl_b32 s72, s65, 5
  s_add_u32 s71, s71, s72
  s_add_u32 s71, s71, 1048576
  v_add_u32 v25, s71, v31
  v_lshlrev_b32 v26, 8, v2
  v_add_u32 v26, 26624, v26
  v_lshrrev_b32 v27, 2, v2
  v_lshl_add_u32 v27, v3, 3, v27
  v_lshlrev_b32 v27, 7, v27
  v_and_b32 v7, 3, v2
  v_lshl_add_u32 v27, v7, 3, v27
  v_lshrrev_b32 v7, 3, v2
  v_and_b32 v30, 1, v3
  v_lshl_or_b32 v7, v30, 1, v7
  v_xor_b32 v7, s66, v7
  v_lshl_add_u32 v27, v7, 5, v27
  v_add_u32 v27, 147456, v27
  s_cmp_eq_u32 s66, 1
  s_cbranch_scc0 L_ow_7
  s_waitcnt vmcnt(0)
L_ow_7:
  s_barrier
  s_branch L_p0_join
L_p0_23:
  v_mov_b32 v64, 0
  v_mov_b32 v65, 0
  v_mov_b32 v66, 0
  v_mov_b32 v67, 0
  v_lshrrev_b32 v38, 1, v2
  v_mul_u32_u24 v38, 4160, v38
  v_and_b32 v39, 1, v2
  v_lshl_add_u32 v38, v39, 4, v38
  ds_write_b128 v38, v[64:67] offset:0
  ds_write_b128 v4, v[64:67] offset:41472
  ds_write_b32 v64, v64 offset:52224
  v_cmp_eq_u32 vcc, 0x80, v0
  s_waitcnt vmcnt(2)
  s_nop 0
  v_cndmask_b32 v104, v104, v29, vcc
  v_cndmask_b32 v105, v105, v29, vcc
  v_alignbit_b32 v40, v105, v104, 16
  v_alignbit_b32 v41, v106, v105, 16
  v_alignbit_b32 v42, v107, v106, 16
  v_alignbit_b32 v43, v108, v107, 16
  v_mov_b32 v44, v105
  v_mov_b32 v45, v106
  v_mov_b32 v46, v107
  v_mov_b32 v47, v108
  v_alignbit_b32 v48, v106, v105, 16
  v_alignbit_b32 v49, v107, v106, 16
  v_alignbit_b32 v50, v108, v107, 16
  v_alignbit_b32 v51, v109, v108, 16
  ds_write_b128 v20, v[40:43] offset:32
  ds_write_b128 v20, v[44:47] offset:4192
  ds_write_b128 v20, v[48:51] offset:8352
  ds_write_b128 v20, v[106:109] offset:12512
  v_alignbit_b32 v52, v113, v112, 16
  v_alignbit_b32 v53, v114, v113, 16
  v_alignbit_b32 v54, v115, v114, 16
  v_alignbit_b32 v55, v116, v115, 16
  v_mov_b32 v56, v113
  v_mov_b32 v57, v114
  v_mov_b32 v58, v115
  v_mov_b32 v59, v116
  v_alignbit_b32 v60, v114, v113, 16
  v_alignbit_b32 v61, v115, v114, 16
  v_alignbit_b32 v62, v116, v115, 16
  v_alignbit_b32 v63, v117, v116, 16
  ds_write_b128 v20, v[52:55] offset:2080
  ds_write_b128 v20, v[56:59] offset:6240
  ds_write_b128 v20, v[60:63] offset:10400
  ds_write_b128 v20, v[114:117] offset:14560
  s_waitcnt lgkmcnt(0)
  v_cndmask_b32 v120, v120, v29, vcc
  v_cndmask_b32 v121, v121, v29, vcc
  v_alignbit_b32 v40, v121, v120, 16
  v_alignbit_b32 v41, v122, v121, 16
  v_alignbit_b32 v42, v123, v122, 16
  v_alignbit_b32 v43, v124, v123, 16
  v_mov_b32 v44, v121
  v_mov_b32 v45, v122
  v_mov_b32 v46, v123
  v_mov_b32 v47, v124
  v_alignbit_b32 v48, v122, v121, 16
  v_alignbit_b32 v49, v123, v122, 16
  v_alignbit_b32 v50, v124, v123, 16
  v_alignbit_b32 v51, v125, v124, 16
  ds_write_b128 v20, v[40:43] offset:16672
  ds_write_b128 v20, v[44:47] offset:20832
  ds_write_b128 v20, v[48:51] offset:24992
  ds_write_b128 v20, v[122:125] offset:29152
  v_alignbit_b32 v52, v129, v128, 16
  v_alignbit_b32 v53, v130, v129, 16
  v_alignbit_b32 v54, v131, v130, 16
  v_alignbit_b32 v55, v132, v131, 16
  v_mov_b32 v56, v129
  v_mov_b32 v57, v130
  v_mov_b32 v58, v131
  v_mov_b32 v59, v132
  v_alignbit_b32 v60, v130, v129, 16
  v_alignbit_b32 v61, v131, v130, 16
  v_alignbit_b32 v62, v132, v131, 16
  v_alignbit_b32 v63, v133, v132, 16
  ds_write_b128 v20, v[52:55] offset:18720
  ds_write_b128 v20, v[56:59] offset:22880
  ds_write_b128 v20, v[60:63] offset:27040
  ds_write_b128 v20, v[130:133] offset:31200
  s_cmp_eq_u32 s66, 3
  s_cbranch_scc1 L_p0_q
  s_waitcnt vmcnt(1)
  v_lshlrev_b32 v72, 16, v232
  v_and_b32 v73, s69, v232
  v_mul_f32 v74, 0xbfb8aa3b, v72
  v_mul_f32 v75, 0xbfb8aa3b, v73
  v_exp_f32 v74, v74
  v_exp_f32 v75, v75
  v_lshlrev_b32 v36, 2, v1
  v_add_f32 v74, 1.0, v74
  v_add_f32 v75, 1.0, v75
  v_rcp_f32 v74, v74
  v_rcp_f32 v75, v75
  v_lshlrev_b32 v38, 4, v3
  v_pk_mul_f32 v[72:73], v[72:73], v[74:75]
  v_cvt_pk_bf16_f32 v72, v72, v73
  ds_write_b32 v36, v72 offset:51200
  s_lshl_b32 s70, s67, 3
  s_add_u32 s70, s70, s68
  s_lshl_b32 s70, s70, 9
  s_add_u32 s70, s70, 65536
  v_lshl_add_u32 v36, v1, 3, s70
  v_mov_b32 v28, 0
  v_lshrrev_b32 v37, 2, v2
  v_lshl_add_u32 v37, v3, 3, v37
  v_lshlrev_b32 v37, 7, v37
  v_and_b32 v39, 3, v2
  v_lshl_add_u32 v37, v39, 3, v37
  v_add_u32 v37, 81920, v37
  v_lshrrev_b32 v39, 3, v2
  v_and_b32 v35, 1, v3
  v_lshl_or_b32 v39, v35, 1, v39
  s_cmp_lt_u32 s2, 192
  s_cselect_b32 s72, 0, 0x80000000
  s_and_b32 s70, s2, 3
  s_mul_i32 s70, s70, 12288
  s_lshr_b32 s71, s2, 2
  s_lshl_b32 s71, s71, 8
  s_add_u32 s70, s70, s71
  s_add_u32 s70, s70, s72
  s_add_u32 s70, s70, 524288
  v_add_u32 v35, s70, v38
  v_xor_b32 v34, 0, v39
  v_lshl_add_u32 v40, v34, 5, v37
  v_xor_b32 v34, 1, v39
  v_lshl_add_u32 v41, v34, 5, v37
  v_xor_b32 v34, 2, v39
  v_lshl_add_u32 v42, v34, 5, v37
  v_xor_b32 v34, 3, v39
  v_lshl_add_u32 v43, v34, 5, v37
  s_waitcnt lgkmcnt(0)
  ds_read_b128 v[128:131], v38 offset:51200
  ds_read_b128 v[132:135], v38 offset:51264
  ds_read_b128 v[136:139], v38 offset:51328
  ds_read_b128 v[140:143], v38 offset:51392
  s_barrier
  s_lshr_b32 s70, s2, 2
  s_lshl_b32 s70, s70, 7
  s_and_b32 s71, s2, 3
  s_mul_i32 s71, s71, 786432
  s_add_u32 s70, s70, s71
  s_add_u32 s70, s70, s72
  v_mul_u32_u24 v18, 6144, v16
  v_and_b32 v19, 7, v1
  v_bfe_u32 v22, v1, 4, 1
  v_lshlrev_b32 v22, 1, v22
  v_xor_b32 v19, v19, v22
  v_lshl_add_u32 v18, v19, 4, v18
  v_add_u32 v18, s70, v18
  v_xor_b32 v19, 64, v18
  s_mov_b32 m0, 81920
  s_mov_b32 s73, 0
  buffer_load_dwordx4 v18, s[48:51], s73 offen nt lds
  s_add_u32 m0, m0, 1024
  s_add_u32 s73, s73, 49152
  buffer_load_dwordx4 v19, s[48:51], s73 offen nt lds
  s_add_u32 m0, m0, 1024
  s_add_u32 s73, s73, 49152
  buffer_load_dwordx4 v18, s[48:51], s73 offen nt lds
  s_add_u32 m0, m0, 1024
  s_add_u32 s73, s73, 49152
  buffer_load_dwordx4 v19, s[48:51], s73 offen nt lds
  s_add_u32 m0, m0, 1024
  s_add_u32 s73, s73, 49152
  buffer_load_dwordx4 v18, s[48:51], s73 offen nt lds
  s_add_u32 m0, m0, 1024
  s_add_u32 s73, s73, 49152
  buffer_load_dwordx4 v19, s[48:51], s73 offen nt lds
  s_add_u32 m0, m0, 1024
  s_add_u32 s73, s73, 49152
  buffer_load_dwordx4 v18, s[48:51], s73 offen nt lds
  s_add_u32 m0, m0, 1024
  s_add_u32 s73, s73, 49152
  buffer_load_dwordx4 v19, s[48:51], s73 offen nt lds
  s_add_u32 m0, m0, 1024
  s_add_u32 s73, s73, 49152
  buffer_load_dwordx4 v18, s[48:51], s73 offen nt lds
  s_add_u32 m0, m0, 1024
  s_add_u32 s73, s73, 49152
  buffer_load_dwordx4 v19, s[48:51], s73 offen nt lds
  s_add_u32 m0, m0, 1024
  s_add_u32 s73, s73, 49152
  buffer_load_dwordx4 v18, s[48:51], s73 offen nt lds
  s_add_u32 m0, m0, 1024
  s_add_u32 s73, s73, 49152
  buffer_load_dwordx4 v19, s[48:51], s73 offen nt lds
  s_add_u32 m0, m0, 1024
  s_add_u32 s73, s73, 49152
  buffer_load_dwordx4 v18, s[48:51], s73 offen nt lds
  s_add_u32 m0, m0, 1024
  s_add_u32 s73, s73, 49152
  buffer_load_dwordx4 v19, s[48:51], s73 offen nt lds
  s_add_u32 m0, m0, 1024
  s_add_u32 s73, s73, 49152
  buffer_load_dwordx4 v18, s[48:51], s73 offen nt lds
  s_add_u32 m0, m0, 1024
  s_add_u32 s73, s73, 49152
  buffer_load_dwordx4 v19, s[48:51], s73 offen nt lds
  buffer_store_dwordx2 v[28:29], v36, s[60:63], 0 offen sc1
  s_waitcnt vmcnt(13)
  ds_read_b64_tr_b16 v[192:193], v40 offset:0
  ds_read_b64_tr_b16 v[194:195], v40 offset:512
  ds_read_b64_tr_b16 v[196:197], v41 offset:0
  ds_read_b64_tr_b16 v[198:199], v41 offset:512
  ds_read_b64_tr_b16 v[200:201], v42 offset:0
  ds_read_b64_tr_b16 v[202:203], v42 offset:512
  ds_read_b64_tr_b16 v[204:205], v43 offset:0
  ds_read_b64_tr_b16 v[206:207], v43 offset:512
  s_waitcnt lgkmcnt(0)
  v_mfma_f32_16x16x32_bf16 v[72:75], v[192:195], v[128:131], 0
  v_mfma_f32_16x16x32_bf16 v[76:79], v[196:199], v[128:131], 0
  v_mfma_f32_16x16x32_bf16 v[80:83], v[200:203], v[128:131], 0
  v_mfma_f32_16x16x32_bf16 v[84:87], v[204:207], v[128:131], 0
  s_waitcnt vmcnt(9)
  ds_read_b64_tr_b16 v[208:209], v40 offset:4096
  ds_read_b64_tr_b16 v[210:211], v40 offset:4608
  ds_read_b64_tr_b16 v[212:213], v41 offset:4096
  ds_read_b64_tr_b16 v[214:215], v41 offset:4608
  ds_read_b64_tr_b16 v[216:217], v42 offset:4096
  ds_read_b64_tr_b16 v[218:219], v42 offset:4608
  ds_read_b64_tr_b16 v[220:221], v43 offset:4096
  ds_read_b64_tr_b16 v[222:223], v43 offset:4608
  s_waitcnt lgkmcnt(0)
  v_mfma_f32_16x16x32_bf16 v[72:75], v[208:211], v[132:135], v[72:75]
  v_mfma_f32_16x16x32_bf16 v[76:79], v[212:215], v[132:135], v[76:79]
  v_mfma_f32_16x16x32_bf16 v[80:83], v[216:219], v[132:135], v[80:83]
  v_mfma_f32_16x16x32_bf16 v[84:87], v[220:223], v[132:135], v[84:87]
  s_waitcnt vmcnt(5)
  ds_read_b64_tr_b16 v[192:193], v40 offset:8192
  ds_read_b64_tr_b16 v[194:195], v40 offset:8704
  ds_read_b64_tr_b16 v[196:197], v41 offset:8192
  ds_read_b64_tr_b16 v[198:199], v41 offset:8704
  ds_read_b64_tr_b16 v[200:201], v42 offset:8192
  ds_read_b64_tr_b16 v[202:203], v42 offset:8704
  ds_read_b64_tr_b16 v[204:205], v43 offset:8192
  ds_read_b64_tr_b16 v[206:207], v43 offset:8704
  s_waitcnt lgkmcnt(0)
  v_mfma_f32_16x16x32_bf16 v[72:75], v[192:195], v[136:139], v[72:75]
  v_mfma_f32_16x16x32_bf16 v[76:79], v[196:199], v[136:139], v[76:79]
  v_mfma_f32_16x16x32_bf16 v[80:83], v[200:203], v[136:139], v[80:83]
  v_mfma_f32_16x16x32_bf16 v[84:87], v[204:207], v[136:139], v[84:87]
  s_waitcnt vmcnt(1)
  s_barrier
  ds_read_b64_tr_b16 v[208:209], v40 offset:12288
  ds_read_b64_tr_b16 v[210:211], v40 offset:12800
  ds_read_b64_tr_b16 v[212:213], v41 offset:12288
  ds_read_b64_tr_b16 v[214:215], v41 offset:12800
  ds_read_b64_tr_b16 v[216:217], v42 offset:12288
  ds_read_b64_tr_b16 v[218:219], v42 offset:12800
  ds_read_b64_tr_b16 v[220:221], v43 offset:12288
  ds_read_b64_tr_b16 v[222:223], v43 offset:12800
  s_waitcnt lgkmcnt(0)
  v_mfma_f32_16x16x32_bf16 v[72:75], v[208:211], v[140:143], v[72:75]
  v_mfma_f32_16x16x32_bf16 v[76:79], v[212:215], v[140:143], v[76:79]
  v_mfma_f32_16x16x32_bf16 v[80:83], v[216:219], v[140:143], v[80:83]
  v_mfma_f32_16x16x32_bf16 v[84:87], v[220:223], v[140:143], v[84:87]
  s_mov_b32 exec_lo, 0x00010001
  s_mov_b32 exec_hi, 0x00010001
  s_nop 2
  buffer_store_dwordx4 v[72:75], v35, s[60:63], 0 offen offset:0 sc1
  buffer_store_dwordx4 v[76:79], v35, s[60:63], 0 offen offset:64 sc1
  buffer_store_dwordx4 v[80:83], v35, s[60:63], 0 offen offset:128 sc1
  buffer_store_dwordx4 v[84:87], v35, s[60:63], 0 offen offset:192 sc1
  s_mov_b64 exec, -1
  s_branch L_p0_b
L_p0_q:
  v_add_u32 v21, 72960, v21
  v_mov_b32 v39, 0x3f803f80
  s_lshl_b32 s70, s65, 13
  s_lshl_b32 s71, s64, 18
  s_add_u32 s70, s70, s71
  s_add_u32 s70, s70, 3145728
  v_add_u32 v38, s70, v4
  s_lshr_b32 s70, s2, 5
  s_lshl_b32 s70, s70, 10
  s_and_b32 s72, s2, 1
  s_lshl_b32 s72, s72, 9
  s_add_u32 s70, s70, s72
  s_bfe_u32 s72, s2, 0x40001
  s_lshl_b32 s72, s72, 4
  s_add_u32 s70, s70, s72
  s_add_u32 s70, s70, 217088
  v_lshrrev_b32 v36, 1, v3
  v_lshlrev_b32 v36, 8, v36
  v_and_b32 v37, 1, v3
  v_lshl_add_u32 v36, v37, 3, v36
  v_lshl_add_u32 v36, v2, 2, v36
  v_add_u32 v36, s70, v36
  s_waitcnt lgkmcnt(0)
  s_barrier
  s_lshl_b32 s70, s2, 13
  v_add_u32 v28, s70, v4
  s_mov_b32 m0, 72960
  s_mov_b32 s73, 0
  buffer_load_dwordx4 v[136:139], v28, s[4:7], 0 offen offset:0 nt
  buffer_load_dwordx4 v[140:143], v28, s[4:7], 0 offen offset:1024 nt
  buffer_load_dwordx4 v[144:147], v28, s[4:7], 0 offen offset:2048 nt
  buffer_load_dwordx4 v[148:151], v28, s[4:7], 0 offen offset:3072 nt
  buffer_load_dwordx4 v[152:155], v28, s[4:7], s74 offen offset:0 nt
  buffer_load_dwordx4 v[156:159], v28, s[4:7], s74 offen offset:1024 nt
  buffer_load_dwordx4 v[160:163], v28, s[4:7], s74 offen offset:2048 nt
  buffer_load_dwordx4 v[164:167], v28, s[4:7], s74 offen offset:3072 nt
  buffer_load_dwordx4 v17, s[4:7], s73 offen nt lds
  s_add_u32 m0, m0, 1024
  s_add_u32 s73, s73, 8192
  buffer_load_dwordx4 v17, s[4:7], s73 offen nt lds
  s_add_u32 m0, m0, 1024
  s_add_u32 s73, s73, 8192
  buffer_load_dwordx4 v17, s[4:7], s73 offen nt lds
  s_add_u32 m0, m0, 1024
  s_add_u32 s73, s73, 8192
  buffer_load_dwordx4 v17, s[4:7], s73 offen nt lds
  s_add_u32 m0, m0, 1024
  s_add_u32 s73, s73, 8192
  buffer_load_dwordx4 v17, s[4:7], s73 offen nt lds
  s_add_u32 m0, m0, 1024
  s_add_u32 s73, s73, 8192
  buffer_load_dwordx4 v17, s[4:7], s73 offen nt lds
  s_add_u32 m0, m0, 1024
  s_add_u32 s73, s73, 8192
  buffer_load_dwordx4 v17, s[4:7], s73 offen nt lds
  s_add_u32 m0, m0, 1024
  s_add_u32 s73, s73, 8192
  buffer_load_dwordx4 v17, s[4:7], s73 offen nt lds
  s_mov_b32 s73, 8192
  s_waitcnt vmcnt(14)
  v_dot2_f32_bf16 v40, v136, v39, 0
  v_dot2_f32_bf16 v41, v136, v136, 0
  v_dot2_f32_bf16 v40, v137, v39, v40
  v_dot2_f32_bf16 v41, v137, v137, v41
  v_dot2_f32_bf16 v40, v138, v39, v40
  v_dot2_f32_bf16 v41, v138, v138, v41
  v_dot2_f32_bf16 v40, v139, v39, v40
  v_dot2_f32_bf16 v41, v139, v139, v41
  v_dot2_f32_bf16 v42, v140, v39, 0
  v_dot2_f32_bf16 v43, v140, v140, 0
  v_dot2_f32_bf16 v42, v141, v39, v42
  v_dot2_f32_bf16 v43, v141, v141, v43
  v_dot2_f32_bf16 v42, v142, v39, v42
  v_dot2_f32_bf16 v43, v142, v142, v43
  v_dot2_f32_bf16 v42, v143, v39, v42
  v_dot2_f32_bf16 v43, v143, v143, v43
  s_waitcnt vmcnt(12)
  v_dot2_f32_bf16 v44, v144, v39, 0
  v_dot2_f32_bf16 v45, v144, v144, 0
  v_dot2_f32_bf16 v44, v145, v39, v44
  v_dot2_f32_bf16 v45, v145, v145, v45
  v_dot2_f32_bf16 v44, v146, v39, v44
  v_dot2_f32_bf16 v45, v146, v146, v45
  v_dot2_f32_bf16 v44, v147, v39, v44
  v_dot2_f32_bf16 v45, v147, v147, v45
  v_dot2_f32_bf16 v46, v148, v39, 0
  v_dot2_f32_bf16 v47, v148, v148, 0
  v_dot2_f32_bf16 v46, v149, v39, v46
  v_dot2_f32_bf16 v47, v149, v149, v47
  v_dot2_f32_bf16 v46, v150, v39, v46
  v_dot2_f32_bf16 v47, v150, v150, v47
  v_dot2_f32_bf16 v46, v151, v39, v46
  v_dot2_f32_bf16 v47, v151, v151, v47
  s_waitcnt vmcnt(10)
  v_dot2_f32_bf16 v48, v152, v39, 0
  v_dot2_f32_bf16 v49, v152, v152, 0
  v_dot2_f32_bf16 v48, v153, v39, v48
  v_dot2_f32_bf16 v49, v153, v153, v49
  v_dot2_f32_bf16 v48, v154, v39, v48
  v_dot2_f32_bf16 v49, v154, v154, v49
  v_dot2_f32_bf16 v48, v155, v39, v48
  v_dot2_f32_bf16 v49, v155, v155, v49
  v_dot2_f32_bf16 v50, v156, v39, 0
  v_dot2_f32_bf16 v51, v156, v156, 0
  v_dot2_f32_bf16 v50, v157, v39, v50
  v_dot2_f32_bf16 v51, v157, v157, v51
  v_dot2_f32_bf16 v50, v158, v39, v50
  v_dot2_f32_bf16 v51, v158, v158, v51
  v_dot2_f32_bf16 v50, v159, v39, v50
  v_dot2_f32_bf16 v51, v159, v159, v51
  s_waitcnt vmcnt(8)
  v_dot2_f32_bf16 v52, v160, v39, 0
  v_dot2_f32_bf16 v53, v160, v160, 0
  v_dot2_f32_bf16 v52, v161, v39, v52
  v_dot2_f32_bf16 v53, v161, v161, v53
  v_dot2_f32_bf16 v52, v162, v39, v52
  v_dot2_f32_bf16 v53, v162, v162, v53
  v_dot2_f32_bf16 v52, v163, v39, v52
  v_dot2_f32_bf16 v53, v163, v163, v53
  v_dot2_f32_bf16 v54, v164, v39, 0
  v_dot2_f32_bf16 v55, v164, v164, 0
  v_dot2_f32_bf16 v54, v165, v39, v54
  v_dot2_f32_bf16 v55, v165, v165, v55
  v_dot2_f32_bf16 v54, v166, v39, v54
  v_dot2_f32_bf16 v55, v166, v166, v55
  v_dot2_f32_bf16 v54, v167, v39, v54
  v_dot2_f32_bf16 v55, v167, v167, v55
  v_permlane32_swap_b32 v40, v48
  v_permlane32_swap_b32 v41, v49
  v_permlane32_swap_b32 v42, v50
  v_permlane32_swap_b32 v43, v51
  v_permlane32_swap_b32 v44, v52
  v_permlane32_swap_b32 v45, v53
  v_permlane32_swap_b32 v46, v54
  v_permlane32_swap_b32 v47, v55
  v_add_f32 v40, v40, v48
  v_add_f32 v41, v41, v49
  v_add_f32 v42, v42, v50
  v_add_f32 v43, v43, v51
  v_add_f32 v44, v44, v52
  v_add_f32 v45, v45, v53
  v_add_f32 v46, v46, v54
  v_add_f32 v47, v47, v55
  v_permlane16_swap_b32 v40, v44
  v_permlane16_swap_b32 v41, v45
  v_permlane16_swap_b32 v42, v46
  v_permlane16_swap_b32 v43, v47
  v_add_f32 v40, v40, v44
  v_add_f32 v41, v41, v45
  v_add_f32 v42, v42, v46
  v_add_f32 v43, v43, v47
  v_add_f32_dpp v40, v40, v40 row_ror:1 row_mask:0xf bank_mask:0xf
  v_add_f32_dpp v41, v41, v41 row_ror:1 row_mask:0xf bank_mask:0xf
  v_add_f32_dpp v42, v42, v42 row_ror:1 row_mask:0xf bank_mask:0xf
  v_add_f32_dpp v43, v43, v43 row_ror:1 row_mask:0xf bank_mask:0xf
  v_add_f32_dpp v40, v40, v40 row_ror:2 row_mask:0xf bank_mask:0xf
  v_add_f32_dpp v41, v41, v41 row_ror:2 row_mask:0xf bank_mask:0xf
  v_add_f32_dpp v42, v42, v42 row_ror:2 row_mask:0xf bank_mask:0xf
  v_add_f32_dpp v43, v43, v43 row_ror:2 row_mask:0xf bank_mask:0xf
  v_add_f32_dpp v40, v40, v40 row_ror:4 row_mask:0xf bank_mask:0xf
  v_add_f32_dpp v41, v41, v41 row_ror:4 row_mask:0xf bank_mask:0xf
  v_add_f32_dpp v42, v42, v42 row_ror:4 row_mask:0xf bank_mask:0xf
  v_add_f32_dpp v43, v43, v43 row_ror:4 row_mask:0xf bank_mask:0xf
  v_add_f32_dpp v40, v40, v40 row_ror:8 row_mask:0xf bank_mask:0xf
  v_add_f32_dpp v41, v41, v41 row_ror:8 row_mask:0xf bank_mask:0xf
  v_add_f32_dpp v42, v42, v42 row_ror:8 row_mask:0xf bank_mask:0xf
  v_add_f32_dpp v43, v43, v43 row_ror:8 row_mask:0xf bank_mask:0xf
  s_waitcnt vmcnt(0)
  s_barrier
  ds_read_b64_tr_b16 v[168:169], v21 offset:0
  ds_read_b64_tr_b16 v[170:171], v21 offset:512
  ds_read_b64_tr_b16 v[172:173], v21 offset:1024
  ds_read_b64_tr_b16 v[174:175], v21 offset:1536
  ds_read_b64_tr_b16 v[176:177], v21 offset:2048
  ds_read_b64_tr_b16 v[178:179], v21 offset:2560
  ds_read_b64_tr_b16 v[180:181], v21 offset:3072
  ds_read_b64_tr_b16 v[182:183], v21 offset:3584
  ds_read_b64_tr_b16 v[184:185], v21 offset:4096
  ds_read_b64_tr_b16 v[186:187], v21 offset:4608
  ds_read_b64_tr_b16 v[188:189], v21 offset:5120
  ds_read_b64_tr_b16 v[190:191], v21 offset:5632
  ds_read_b64_tr_b16 v[192:193], v21 offset:6144
  ds_read_b64_tr_b16 v[194:195], v21 offset:6656
  ds_read_b64_tr_b16 v[196:197], v21 offset:7168
  ds_read_b64_tr_b16 v[198:199], v21 offset:7680
  v_cmp_eq_u32 vcc, 1, v2
  s_nop 1
  v_cndmask_b32 v40, v40, v42, vcc
  v_cndmask_b32 v41, v41, v43, vcc
  v_mul_f32 v40, 0xbb000000, v40
  v_mul_f32 v42, v40, v40
  v_mov_b32 v43, 0x3b000000
  v_fma_f32 v41, v41, v43, -v42
  v_max_f32 v41, 0, v41
  v_add_f32 v41, 0x3727c5ac, v41
  v_rsq_f32 v41, v41
  s_mov_b32 exec_lo, 0x00030003
  v_mul_f32 v40, v40, v41
  s_mov_b32 exec_hi, 0x00030003
  buffer_store_dword v41, v36, s[60:63], 0 offen sc1
  buffer_store_dword v40, v36, s[60:63], s73 offen sc1
  s_mov_b64 exec, -1
  s_waitcnt lgkmcnt(14)
  buffer_store_dwordx4 v[168:171], v38, s[60:63], 0 offen offset:0 sc1
  s_waitcnt lgkmcnt(12)
  buffer_store_dwordx4 v[172:175], v38, s[60:63], 0 offen offset:1024 sc1
  s_waitcnt lgkmcnt(10)
  buffer_store_dwordx4 v[176:179], v38, s[60:63], 0 offen offset:2048 sc1
  s_waitcnt lgkmcnt(8)
  buffer_store_dwordx4 v[180:183], v38, s[60:63], 0 offen offset:3072 sc1
  s_waitcnt lgkmcnt(6)
  buffer_store_dwordx4 v[184:187], v38, s[60:63], s74 offen offset:0 sc1
  s_waitcnt lgkmcnt(4)
  buffer_store_dwordx4 v[188:191], v38, s[60:63], s74 offen offset:1024 sc1
  s_waitcnt lgkmcnt(2)
  buffer_store_dwordx4 v[192:195], v38, s[60:63], s74 offen offset:2048 sc1
  s_waitcnt lgkmcnt(0)
  buffer_store_dwordx4 v[196:199], v38, s[60:63], s74 offen offset:3072 sc1
L_p0_b:
  v_and_b32 v32, 7, v1
  v_xor_b32 v32, v16, v32
  v_lshlrev_b32 v32, 4, v32
  v_lshl_add_u32 v32, v16, 12, v32
  s_lshl_b32 s70, s67, 18
  s_lshl_b32 s71, s66, 10
  s_add_u32 s70, s70, s71
  v_add_u32 v8, s70, v32
  s_lshl_b32 s84, s66, 14
  s_add_u32 s84, s84, 81920
  s_and_b32 s85, s68, 3
  s_lshl_b32 s85, s85, 8
  v_and_b32 v32, 7, v2
  v_xor_b32 v32, v32, v3
  v_lshlrev_b32 v32, 4, v32
  v_lshl_add_u32 v32, v2, 7, v32
  v_add_u32 v10, s84, v32
  v_xor_b32 v11, 64, v10
  s_add_u32 s80, s66, 0
  s_and_b32 s80, s80, 3
  s_lshl_b32 s80, s80, 16
  s_add_u32 s81, s66, 1
  s_and_b32 s81, s81, 3
  s_lshl_b32 s81, s81, 16
  s_add_u32 s82, s66, 2
  s_and_b32 s82, s82, 3
  s_lshl_b32 s82, s82, 16
  s_add_u32 s83, s66, 3
  s_and_b32 s83, s83, 3
  s_lshl_b32 s83, s83, 16
  s_lshr_b32 s70, s66, 1
  s_add_u32 s78, s76, s70
  s_and_b32 s79, s66, 1
  s_mul_i32 s71, s70, 16640
  s_lshl_b32 s72, s79, 8
  s_add_u32 s71, s71, s72
  s_add_u32 s71, s71, 8
  v_and_b32 v25, 3, v2
  v_mul_u32_u24 v25, 4160, v25
  v_lshrrev_b32 v26, 2, v2
  v_lshl_add_u32 v25, v26, 3, v25
  v_lshl_add_u32 v25, v3, 4, v25
  v_add_u32 v13, s71, v25
  s_lshl_b32 s72, s79, 4
  s_add_u32 s72, s72, 30
  v_lshlrev_b32 v25, 1, v2
  v_sub_u32 v25, v3, v25
  v_add_u32 v25, s72, v25
  v_add_u32 v26, 0, v25
  v_bfe_u32 v27, v26, 3, 1
  v_xor_b32 v27, s70, v27
  v_lshlrev_b32 v26, 5, v26
  v_lshl_add_u32 v16, v27, 4, v26
  v_add_u32 v26, 4, v25
  v_bfe_u32 v27, v26, 3, 1
  v_xor_b32 v27, s70, v27
  v_lshlrev_b32 v26, 5, v26
  v_lshl_add_u32 v17, v27, 4, v26
  v_add_u32 v26, 8, v25
  v_bfe_u32 v27, v26, 3, 1
  v_xor_b32 v27, s70, v27
  v_lshlrev_b32 v26, 5, v26
  v_lshl_add_u32 v18, v27, 4, v26
  v_add_u32 v26, 12, v25
  v_bfe_u32 v27, v26, 3, 1
  v_xor_b32 v27, s70, v27
  v_lshlrev_b32 v26, 5, v26
  v_lshl_add_u32 v19, v27, 4, v26
  s_lshl_b32 s72, s64, 8
  s_add_u32 s72, s72, 530432
  v_lshl_add_u32 v20, v1, 2, s72
  s_mul_i32 s72, s66, 384
  s_add_u32 s72, s72, 72960
  v_lshl_add_u32 v21, v1, 2, s72
  v_lshl_add_u32 v15, v1, 1, s72
  v_lshl_add_u32 v28, v3, 5, s72
  v_lshl_add_u32 v29, v3, 4, s72
  s_lshl_b32 s71, s66, 12
  s_add_u32 s71, s71, 217088
  v_add_u32 v22, s71, v4
  s_lshl_b32 s71, s78, 2
  s_add_u32 s71, s71, 524288
  v_and_b32 v23, 3, v1
  v_mul_u32_u24 v23, 12288, v23
  v_bfe_u32 v7, v1, 2, 2
  v_lshl_add_u32 v23, v7, 11, v23
  v_add_u32 v23, s71, v23
  s_lshl_b32 s71, s78, 1
  v_mov_b32 v24, s71
  s_lshl_b32 s71, s64, 18
  s_lshl_b32 s72, s65, 5
  s_add_u32 s71, s71, s72
  s_add_u32 s71, s71, 1048576
  v_add_u32 v25, s71, v31
  v_lshlrev_b32 v26, 8, v2
  v_add_u32 v26, 26624, v26
  v_lshrrev_b32 v27, 2, v2
  v_lshl_add_u32 v27, v3, 3, v27
  v_lshlrev_b32 v27, 7, v27
  v_and_b32 v7, 3, v2
  v_lshl_add_u32 v27, v7, 3, v27
  v_lshrrev_b32 v7, 3, v2
  v_and_b32 v30, 1, v3
  v_lshl_or_b32 v7, v30, 1, v7
  v_xor_b32 v7, s66, v7
  v_lshl_add_u32 v27, v7, 5, v27
  v_add_u32 v27, 147456, v27
  v_mov_b32 v36, 0
  v_mov_b32 v37, 1
  s_waitcnt vmcnt(0)
  s_mov_b64 exec, 1
  ds_add_rtn_u32 v37, v36, v37 offset:52224
  s_mov_b64 exec, -1
  s_waitcnt lgkmcnt(0)
  v_readfirstlane_b32 s70, v37
  s_nop 0
  s_cmp_eq_u32 s70, 0
  s_cbranch_scc1 L_p0_b2
  s_and_b32 s70, s2, 15
  s_lshl_b32 s70, s70, 8
  s_add_u32 s70, s70, 26624
  v_mov_b32 v100, s70
  v_mov_b32 v101, 1
  s_mov_b64 exec, 1
  buffer_atomic_add v101, v100, s[60:63], 0 offen sc0 sc1
  s_mov_b64 exec, -1
L_p0_b2:
L_p0_join:
  s_cmp_eq_u32 s66, 0
  s_cbranch_scc0 L_ow_8
  v_and_b32 v32, 1, v1
  v_lshlrev_b32 v32, 11, v32
  s_lshl_b32 s70, s64, 8
  s_add_u32 s70, s70, 0
  v_add_u32 v32, s70, v32
  s_mov_b32 s77, 0
  s_mov_b64 exec, 0x3
L_poll_9:
  buffer_load_dword v33, v32, s[60:63], 0 offen  sc1
  s_waitcnt vmcnt(0)
  v_cmp_gt_u32 vcc, 16, v33
  s_nop 0
  s_cbranch_vccz L_polld_10
  s_sleep 1
  s_add_u32 s77, s77, 1
  s_cmp_lt_u32 s77, 200000
  s_cbranch_scc1 L_poll_9
L_polld_10:
  s_mov_b64 exec, -1
  s_mov_b32 m0, 33280
  s_mov_b32 s73, 0
  buffer_load_dwordx4 v25, s[60:63], s73 offen sc1 lds
  s_mov_b32 m0, 34304
  s_mov_b32 s73, 32768
  buffer_load_dwordx4 v25, s[60:63], s73 offen sc1 lds
  s_mov_b32 m0, 35328
  s_mov_b32 s73, 65536
  buffer_load_dwordx4 v25, s[60:63], s73 offen sc1 lds
  s_mov_b32 m0, 36352
  s_mov_b32 s73, 98304
  buffer_load_dwordx4 v25, s[60:63], s73 offen sc1 lds
  s_mov_b32 m0, 37376
  s_mov_b32 s73, 131072
  buffer_load_dwordx4 v25, s[60:63], s73 offen sc1 lds
  s_mov_b32 m0, 38400
  s_mov_b32 s73, 163840
  buffer_load_dwordx4 v25, s[60:63], s73 offen sc1 lds
  s_mov_b32 m0, 39424
  s_mov_b32 s73, 196608
  buffer_load_dwordx4 v25, s[60:63], s73 offen sc1 lds
  s_mov_b32 m0, 40448
  s_mov_b32 s73, 229376
  buffer_load_dwordx4 v25, s[60:63], s73 offen sc1 lds
L_ow_8:
  ds_read_b64 a[128:129], v13 offset:0
  ds_read_b64 a[130:131], v13 offset:8
  ds_read_b64 a[132:133], v13 offset:512
  ds_read_b64 a[134:135], v13 offset:520
  ds_read_b64 a[136:137], v13 offset:1024
  ds_read_b64 a[138:139], v13 offset:1032
  ds_read_b64 a[140:141], v13 offset:1536
  ds_read_b64 a[142:143], v13 offset:1544
  ds_read_b64 a[144:145], v13 offset:2048
  ds_read_b64 a[146:147], v13 offset:2056
  ds_read_b64 a[148:149], v13 offset:2560
  ds_read_b64 a[150:151], v13 offset:2568
  ds_read_b64 a[152:153], v13 offset:3072
  ds_read_b64 a[154:155], v13 offset:3080
  ds_read_b64 a[156:157], v13 offset:3584
  ds_read_b64 a[158:159], v13 offset:3592
  s_cmp_eq_u32 s66, 0
  s_cbranch_scc0 L_ow_12
  s_waitcnt vmcnt(0)
L_ow_12:
  s_barrier
  s_add_u32 s4, s80, 0x8000
  s_add_u32 s5, s81, 0x8000
  s_add_u32 s6, s82, 0x8000
  s_add_u32 s7, s83, 0x8000
  buffer_load_ushort v75, v24, s[24:27], 0 offen
  ds_read_b128 a[160:163], v16 offset:40448
  ds_read_b128 a[164:167], v16 offset:39424
  ds_read_b128 a[168:171], v16 offset:38400
  ds_read_b128 a[172:175], v16 offset:37376
  ds_read_b128 a[176:179], v16 offset:36352
  ds_read_b128 a[180:183], v16 offset:35328
  ds_read_b128 a[184:187], v16 offset:34304
  ds_read_b128 a[188:191], v16 offset:33280
  s_mul_i32 s70, s65, 28
  s_lshl_b32 s71, s66, 3
  s_add_u32 s70, s70, s71
  s_lshl_b32 s70, s70, 10
  s_and_b32 s71, s64, 1
  s_lshl_b32 s71, s71, 9
  s_add_u32 s70, s70, s71
  v_lshrrev_b32 v6, 5, v1
  v_lshlrev_b32 v6, 10, v6
  v_and_b32 v103, 31, v1
  v_lshl_add_u32 v6, v103, 4, v6
  v_add_u32 v6, s70, v6
  s_waitcnt lgkmcnt(7)
  v_mfma_f32_16x16x32_bf16 v[32:35], a[128:131], a[160:163], 0
  v_mfma_f32_16x16x32_bf16 v[36:39], a[132:135], a[160:163], 0
  s_add_u32 m0, s84, 0
  s_add_u32 s74, s85, 0
  s_and_b32 s74, s74, 0x3ff
  v_add_u32 v12, s74, v8
  buffer_load_dwordx4 v12, s[32:35], s80 offen lds
  s_add_u32 m0, m0, 1024
  v_mfma_f32_16x16x32_bf16 v[40:43], a[136:139], a[160:163], 0
  v_mfma_f32_16x16x32_bf16 v[44:47], a[140:143], a[160:163], 0
  v_mfma_f32_16x16x32_bf16 v[48:51], a[144:147], a[160:163], 0
  buffer_load_dwordx4 v12, s[32:35], s4 offen lds
  s_add_u32 m0, m0, 1024
  v_mfma_f32_16x16x32_bf16 v[52:55], a[148:151], a[160:163], 0
  v_mfma_f32_16x16x32_bf16 v[56:59], a[152:155], a[160:163], 0
  v_mfma_f32_16x16x32_bf16 v[60:63], a[156:159], a[160:163], 0
  buffer_load_dwordx4 v12, s[32:35], s81 offen lds
  s_add_u32 m0, m0, 1024
  s_waitcnt lgkmcnt(6)
  v_mfma_f32_16x16x32_bf16 v[36:39], a[128:131], a[164:167], v[36:39]
  ds_read_b128 a[224:227], v17 offset:40448
  v_mfma_f32_16x16x32_bf16 v[40:43], a[132:135], a[164:167], v[40:43]
  ds_read_b64 a[192:193], v13 offset:64
  s_waitcnt vmcnt(3)
  v_readfirstlane_b32 s70, v101
  s_nop 0
  s_cmp_lg_u32 s70, 15
  s_cbranch_scc1 L_af_13
  s_mov_b64 exec, 1
  buffer_store_dword v101, v100, s[60:63], 0 offen offset:128 sc1
  s_mov_b64 exec, -1
L_af_13:
  v_mfma_f32_16x16x32_bf16 v[44:47], a[136:139], a[164:167], v[44:47]
  ds_read_b64 a[194:195], v13 offset:72
  buffer_load_dwordx4 v12, s[32:35], s5 offen lds
  s_add_u32 m0, m0, 1024
  v_mfma_f32_16x16x32_bf16 v[48:51], a[140:143], a[164:167], v[48:51]
  ds_read_b128 a[228:231], v17 offset:39424
  v_mfma_f32_16x16x32_bf16 v[52:55], a[144:147], a[164:167], v[52:55]
  ds_read_b64 a[196:197], v13 offset:576
  v_mfma_f32_16x16x32_bf16 v[56:59], a[148:151], a[164:167], v[56:59]
  ds_read_b64 a[198:199], v13 offset:584
  buffer_load_dwordx4 v12, s[32:35], s82 offen lds
  s_add_u32 m0, m0, 1024
  v_mfma_f32_16x16x32_bf16 v[60:63], a[152:155], a[164:167], v[60:63]
  ds_read_b128 a[232:235], v17 offset:38400
  s_waitcnt lgkmcnt(12)
  v_mfma_f32_16x16x32_bf16 v[40:43], a[128:131], a[168:171], v[40:43]
  ds_read_b64 a[200:201], v13 offset:1088
  v_mfma_f32_16x16x32_bf16 v[44:47], a[132:135], a[168:171], v[44:47]
  ds_read_b64 a[202:203], v13 offset:1096
  buffer_load_dwordx4 v12, s[32:35], s6 offen lds
  s_add_u32 m0, m0, 1024
  v_mfma_f32_16x16x32_bf16 v[48:51], a[136:139], a[168:171], v[48:51]
  ds_read_b128 a[236:239], v17 offset:37376
  v_mfma_f32_16x16x32_bf16 v[52:55], a[140:143], a[168:171], v[52:55]
  ds_read_b64 a[204:205], v13 offset:1600
  v_mfma_f32_16x16x32_bf16 v[56:59], a[144:147], a[168:171], v[56:59]
  ds_read_b64 a[206:207], v13 offset:1608
  buffer_load_dwordx4 v12, s[32:35], s83 offen lds
  s_add_u32 m0, m0, 1024
  v_mfma_f32_16x16x32_bf16 v[60:63], a[148:151], a[168:171], v[60:63]
  ds_read_b128 a[240:243], v17 offset:36352
  s_waitcnt lgkmcnt(15)
  v_mfma_f32_16x16x32_bf16 v[44:47], a[128:131], a[172:175], v[44:47]
  ds_read_b64 a[208:209], v13 offset:2112
  v_mfma_f32_16x16x32_bf16 v[48:51], a[132:135], a[172:175], v[48:51]
  ds_read_b64 a[210:211], v13 offset:2120
  buffer_load_dwordx4 v12, s[32:35], s7 offen lds
  v_mfma_f32_16x16x32_bf16 v[52:55], a[136:139], a[172:175], v[52:55]
  ds_read_b128 a[244:247], v17 offset:35328
  v_mfma_f32_16x16x32_bf16 v[56:59], a[140:143], a[172:175], v[56:59]
  ds_read_b64 a[212:213], v13 offset:2624
  v_mfma_f32_16x16x32_bf16 v[60:63], a[144:147], a[172:175], v[60:63]
  ds_read_b64 a[214:215], v13 offset:2632
  s_add_u32 m0, s84, 8192
  s_add_u32 s74, s85, 128
  s_and_b32 s74, s74, 0x3ff
  v_add_u32 v12, s74, v8
  buffer_load_dwordx4 v12, s[32:35], s80 offen lds
  s_add_u32 m0, m0, 1024
  s_waitcnt lgkmcnt(15)
  v_mfma_f32_16x16x32_bf16 v[48:51], a[128:131], a[176:179], v[48:51]
  ds_read_b128 a[248:251], v17 offset:34304
  v_mfma_f32_16x16x32_bf16 v[52:55], a[132:135], a[176:179], v[52:55]
  ds_read_b64 a[216:217], v13 offset:3136
  v_mfma_f32_16x16x32_bf16 v[56:59], a[136:139], a[176:179], v[56:59]
  ds_read_b64 a[218:219], v13 offset:3144
  buffer_load_dwordx4 v12, s[32:35], s4 offen lds
  s_add_u32 m0, m0, 1024
  v_mfma_f32_16x16x32_bf16 v[60:63], a[140:143], a[176:179], v[60:63]
  ds_read_b128 a[252:255], v17 offset:33280
  s_waitcnt lgkmcnt(15)
  v_mfma_f32_16x16x32_bf16 v[52:55], a[128:131], a[180:183], v[52:55]
  ds_read_b64 a[220:221], v13 offset:3648
  v_mfma_f32_16x16x32_bf16 v[56:59], a[132:135], a[180:183], v[56:59]
  ds_read_b64 a[222:223], v13 offset:3656
  buffer_load_dwordx4 v12, s[32:35], s81 offen lds
  s_add_u32 m0, m0, 1024
  v_mfma_f32_16x16x32_bf16 v[60:63], a[136:139], a[180:183], v[60:63]
  s_waitcnt lgkmcnt(15)
  v_mfma_f32_16x16x32_bf16 v[56:59], a[128:131], a[184:187], v[56:59]
  v_mfma_f32_16x16x32_bf16 v[60:63], a[132:135], a[184:187], v[60:63]
  buffer_load_dwordx4 v12, s[32:35], s5 offen lds
  s_add_u32 m0, m0, 1024
  s_waitcnt lgkmcnt(15)
  v_mfma_f32_16x16x32_bf16 v[60:63], a[128:131], a[188:191], v[60:63]
  s_waitcnt lgkmcnt(0)
  v_mfma_f32_16x16x32_bf16 v[32:35], a[192:195], a[224:227], v[32:35]
  ds_read_b128 a[160:163], v18 offset:40448
  v_mfma_f32_16x16x32_bf16 v[36:39], a[192:195], a[228:231], v[36:39]
  ds_read_b64 a[128:129], v13 offset:128
  buffer_load_dwordx4 v12, s[32:35], s82 offen lds
  s_add_u32 m0, m0, 1024
  v_mfma_f32_16x16x32_bf16 v[36:39], a[196:199], a[224:227], v[36:39]
  ds_read_b64 a[130:131], v13 offset:136
  v_mfma_f32_16x16x32_bf16 v[40:43], a[196:199], a[228:231], v[40:43]
  ds_read_b128 a[164:167], v18 offset:39424
  v_mfma_f32_16x16x32_bf16 v[40:43], a[192:195], a[232:235], v[40:43]
  ds_read_b64 a[132:133], v13 offset:640
  buffer_load_dwordx4 v12, s[32:35], s6 offen lds
  s_add_u32 m0, m0, 1024
  v_mfma_f32_16x16x32_bf16 v[44:47], a[196:199], a[232:235], v[44:47]
  ds_read_b64 a[134:135], v13 offset:648
  v_mfma_f32_16x16x32_bf16 v[40:43], a[200:203], a[224:227], v[40:43]
  ds_read_b128 a[168:171], v18 offset:38400
  v_mfma_f32_16x16x32_bf16 v[44:47], a[200:203], a[228:231], v[44:47]
  ds_read_b64 a[136:137], v13 offset:1152
  buffer_load_dwordx4 v12, s[32:35], s83 offen lds
  s_add_u32 m0, m0, 1024
  v_mfma_f32_16x16x32_bf16 v[48:51], a[200:203], a[232:235], v[48:51]
  ds_read_b64 a[138:139], v13 offset:1160
  v_mfma_f32_16x16x32_bf16 v[44:47], a[192:195], a[236:239], v[44:47]
  ds_read_b128 a[172:175], v18 offset:37376
  v_mfma_f32_16x16x32_bf16 v[48:51], a[196:199], a[236:239], v[48:51]
  ds_read_b64 a[140:141], v13 offset:1664
  buffer_load_dwordx4 v12, s[32:35], s7 offen lds
  v_mfma_f32_16x16x32_bf16 v[52:55], a[200:203], a[236:239], v[52:55]
  ds_read_b64 a[142:143], v13 offset:1672
  v_mfma_f32_16x16x32_bf16 v[44:47], a[204:207], a[224:227], v[44:47]
  ds_read_b128 a[176:179], v18 offset:36352
  v_mfma_f32_16x16x32_bf16 v[48:51], a[204:207], a[228:231], v[48:51]
  ds_read_b64 a[144:145], v13 offset:2176
  v_mfma_f32_16x16x32_bf16 v[52:55], a[204:207], a[232:235], v[52:55]
  ds_read_b64 a[146:147], v13 offset:2184
  v_mfma_f32_16x16x32_bf16 v[56:59], a[204:207], a[236:239], v[56:59]
  ds_read_b128 a[180:183], v18 offset:35328
  v_mfma_f32_16x16x32_bf16 v[48:51], a[192:195], a[240:243], v[48:51]
  ds_read_b64 a[148:149], v13 offset:2688
  v_mfma_f32_16x16x32_bf16 v[52:55], a[196:199], a[240:243], v[52:55]
  ds_read_b64 a[150:151], v13 offset:2696
  v_mfma_f32_16x16x32_bf16 v[56:59], a[200:203], a[240:243], v[56:59]
  ds_read_b128 a[184:187], v18 offset:34304
  v_mfma_f32_16x16x32_bf16 v[60:63], a[204:207], a[240:243], v[60:63]
  ds_read_b64 a[152:153], v13 offset:3200
  v_mfma_f32_16x16x32_bf16 v[48:51], a[208:211], a[224:227], v[48:51]
  ds_read_b64 a[154:155], v13 offset:3208
  v_mfma_f32_16x16x32_bf16 v[52:55], a[208:211], a[228:231], v[52:55]
  ds_read_b128 a[188:191], v18 offset:33280
  v_mfma_f32_16x16x32_bf16 v[56:59], a[208:211], a[232:235], v[56:59]
  ds_read_b64 a[156:157], v13 offset:3712
  v_mfma_f32_16x16x32_bf16 v[60:63], a[208:211], a[236:239], v[60:63]
  ds_read_b64 a[158:159], v13 offset:3720
  v_mfma_f32_16x16x32_bf16 v[52:55], a[192:195], a[244:247], v[52:55]
  v_mfma_f32_16x16x32_bf16 v[56:59], a[196:199], a[244:247], v[56:59]
  v_mfma_f32_16x16x32_bf16 v[60:63], a[200:203], a[244:247], v[60:63]
  v_mfma_f32_16x16x32_bf16 v[52:55], a[212:215], a[224:227], v[52:55]
  v_mfma_f32_16x16x32_bf16 v[56:59], a[212:215], a[228:231], v[56:59]
  v_mfma_f32_16x16x32_bf16 v[60:63], a[212:215], a[232:235], v[60:63]
  v_mfma_f32_16x16x32_bf16 v[56:59], a[192:195], a[248:251], v[56:59]
  v_mfma_f32_16x16x32_bf16 v[60:63], a[196:199], a[248:251], v[60:63]
  v_mfma_f32_16x16x32_bf16 v[56:59], a[216:219], a[224:227], v[56:59]
  v_mfma_f32_16x16x32_bf16 v[60:63], a[216:219], a[228:231], v[60:63]
  v_mfma_f32_16x16x32_bf16 v[60:63], a[192:195], a[252:255], v[60:63]
  v_mfma_f32_16x16x32_bf16 v[60:63], a[220:223], a[224:227], v[60:63]
  s_waitcnt lgkmcnt(0)
  v_mfma_f32_16x16x32_bf16 v[32:35], a[128:131], a[160:163], v[32:35]
  ds_read_b128 a[224:227], v19 offset:40448
  v_mfma_f32_16x16x32_bf16 v[36:39], a[128:131], a[164:167], v[36:39]
  ds_read_b64 a[192:193], v13 offset:192
  v_mfma_f32_16x16x32_bf16 v[36:39], a[132:135], a[160:163], v[36:39]
  ds_read_b64 a[194:195], v13 offset:200
  v_mfma_f32_16x16x32_bf16 v[40:43], a[132:135], a[164:167], v[40:43]
  ds_read_b128 a[228:231], v19 offset:39424
  v_mfma_f32_16x16x32_bf16 v[40:43], a[128:131], a[168:171], v[40:43]
  ds_read_b64 a[196:197], v13 offset:704
  v_mfma_f32_16x16x32_bf16 v[44:47], a[132:135], a[168:171], v[44:47]
  ds_read_b64 a[198:199], v13 offset:712
  v_mfma_f32_16x16x32_bf16 v[40:43], a[136:139], a[160:163], v[40:43]
  ds_read_b128 a[232:235], v19 offset:38400
  v_mfma_f32_16x16x32_bf16 v[44:47], a[136:139], a[164:167], v[44:47]
  ds_read_b64 a[200:201], v13 offset:1216
  v_mfma_f32_16x16x32_bf16 v[48:51], a[136:139], a[168:171], v[48:51]
  ds_read_b64 a[202:203], v13 offset:1224
  v_mfma_f32_16x16x32_bf16 v[44:47], a[128:131], a[172:175], v[44:47]
  ds_read_b128 a[236:239], v19 offset:37376
  v_mfma_f32_16x16x32_bf16 v[48:51], a[132:135], a[172:175], v[48:51]
  ds_read_b64 a[204:205], v13 offset:1728
  v_mfma_f32_16x16x32_bf16 v[52:55], a[136:139], a[172:175], v[52:55]
  ds_read_b64 a[206:207], v13 offset:1736
  v_mfma_f32_16x16x32_bf16 v[44:47], a[140:143], a[160:163], v[44:47]
  ds_read_b128 a[240:243], v19 offset:36352
  v_mfma_f32_16x16x32_bf16 v[48:51], a[140:143], a[164:167], v[48:51]
  ds_read_b64 a[208:209], v13 offset:2240
  v_mfma_f32_16x16x32_bf16 v[52:55], a[140:143], a[168:171], v[52:55]
  ds_read_b64 a[210:211], v13 offset:2248
  v_mfma_f32_16x16x32_bf16 v[56:59], a[140:143], a[172:175], v[56:59]
  ds_read_b128 a[244:247], v19 offset:35328
  v_mfma_f32_16x16x32_bf16 v[48:51], a[128:131], a[176:179], v[48:51]
  ds_read_b64 a[212:213], v13 offset:2752
  v_mfma_f32_16x16x32_bf16 v[52:55], a[132:135], a[176:179], v[52:55]
  ds_read_b64 a[214:215], v13 offset:2760
  v_mfma_f32_16x16x32_bf16 v[56:59], a[136:139], a[176:179], v[56:59]
  ds_read_b128 a[248:251], v19 offset:34304
  v_mfma_f32_16x16x32_bf16 v[60:63], a[140:143], a[176:179], v[60:63]
  ds_read_b64 a[216:217], v13 offset:3264
  v_mfma_f32_16x16x32_bf16 v[48:51], a[144:147], a[160:163], v[48:51]
  ds_read_b64 a[218:219], v13 offset:3272
  v_mfma_f32_16x16x32_bf16 v[52:55], a[144:147], a[164:167], v[52:55]
  ds_read_b128 a[252:255], v19 offset:33280
  v_mfma_f32_16x16x32_bf16 v[56:59], a[144:147], a[168:171], v[56:59]
  ds_read_b64 a[220:221], v13 offset:3776
  v_mfma_f32_16x16x32_bf16 v[60:63], a[144:147], a[172:175], v[60:63]
  ds_read_b64 a[222:223], v13 offset:3784
  v_mfma_f32_16x16x32_bf16 v[52:55], a[128:131], a[180:183], v[52:55]
  v_mfma_f32_16x16x32_bf16 v[56:59], a[132:135], a[180:183], v[56:59]
  v_mfma_f32_16x16x32_bf16 v[60:63], a[136:139], a[180:183], v[60:63]
  v_mfma_f32_16x16x32_bf16 v[52:55], a[148:151], a[160:163], v[52:55]
  v_mfma_f32_16x16x32_bf16 v[56:59], a[148:151], a[164:167], v[56:59]
  v_mfma_f32_16x16x32_bf16 v[60:63], a[148:151], a[168:171], v[60:63]
  v_mfma_f32_16x16x32_bf16 v[56:59], a[128:131], a[184:187], v[56:59]
  v_mfma_f32_16x16x32_bf16 v[60:63], a[132:135], a[184:187], v[60:63]
  v_mfma_f32_16x16x32_bf16 v[56:59], a[152:155], a[160:163], v[56:59]
  v_mfma_f32_16x16x32_bf16 v[60:63], a[152:155], a[164:167], v[60:63]
  v_mfma_f32_16x16x32_bf16 v[60:63], a[128:131], a[188:191], v[60:63]
  v_mfma_f32_16x16x32_bf16 v[60:63], a[156:159], a[160:163], v[60:63]
  s_waitcnt lgkmcnt(0)
  s_cmp_eq_u32 s66, 0
  s_cbranch_scc0 L_ow_14
  s_mov_b64 exec, 0xffff
  buffer_load_dword v31, v26, s[60:63], 0 offen offset:128 sc1
  s_mov_b64 exec, -1
L_ow_14:
  v_mfma_f32_16x16x32_bf16 v[32:35], a[192:195], a[224:227], v[32:35]
  v_mfma_f32_16x16x32_bf16 v[36:39], a[192:195], a[228:231], v[36:39]
  v_mfma_f32_16x16x32_bf16 v[36:39], a[196:199], a[224:227], v[36:39]
  v_mfma_f32_16x16x32_bf16 v[40:43], a[196:199], a[228:231], v[40:43]
  v_mfma_f32_16x16x32_bf16 v[40:43], a[192:195], a[232:235], v[40:43]
  v_mfma_f32_16x16x32_bf16 v[44:47], a[196:199], a[232:235], v[44:47]
  v_mfma_f32_16x16x32_bf16 v[40:43], a[200:203], a[224:227], v[40:43]
  v_mfma_f32_16x16x32_bf16 v[44:47], a[200:203], a[228:231], v[44:47]
  v_mfma_f32_16x16x32_bf16 v[48:51], a[200:203], a[232:235], v[48:51]
  v_mfma_f32_16x16x32_bf16 v[44:47], a[192:195], a[236:239], v[44:47]
  v_mfma_f32_16x16x32_bf16 v[48:51], a[196:199], a[236:239], v[48:51]
  v_mfma_f32_16x16x32_bf16 v[52:55], a[200:203], a[236:239], v[52:55]
  v_mfma_f32_16x16x32_bf16 v[44:47], a[204:207], a[224:227], v[44:47]
  v_mfma_f32_16x16x32_bf16 v[48:51], a[204:207], a[228:231], v[48:51]
  v_mfma_f32_16x16x32_bf16 v[52:55], a[204:207], a[232:235], v[52:55]
  v_mfma_f32_16x16x32_bf16 v[56:59], a[204:207], a[236:239], v[56:59]
  v_mfma_f32_16x16x32_bf16 v[48:51], a[192:195], a[240:243], v[48:51]
  v_mfma_f32_16x16x32_bf16 v[52:55], a[196:199], a[240:243], v[52:55]
  v_mfma_f32_16x16x32_bf16 v[56:59], a[200:203], a[240:243], v[56:59]
  v_mfma_f32_16x16x32_bf16 v[60:63], a[204:207], a[240:243], v[60:63]
  v_mfma_f32_16x16x32_bf16 v[48:51], a[208:211], a[224:227], v[48:51]
  v_mfma_f32_16x16x32_bf16 v[52:55], a[208:211], a[228:231], v[52:55]
  v_mfma_f32_16x16x32_bf16 v[56:59], a[208:211], a[232:235], v[56:59]
  v_mfma_f32_16x16x32_bf16 v[60:63], a[208:211], a[236:239], v[60:63]
  v_mfma_f32_16x16x32_bf16 v[52:55], a[192:195], a[244:247], v[52:55]
  v_mfma_f32_16x16x32_bf16 v[56:59], a[196:199], a[244:247], v[56:59]
  v_mfma_f32_16x16x32_bf16 v[60:63], a[200:203], a[244:247], v[60:63]
  v_mfma_f32_16x16x32_bf16 v[52:55], a[212:215], a[224:227], v[52:55]
  v_mfma_f32_16x16x32_bf16 v[56:59], a[212:215], a[228:231], v[56:59]
  v_mfma_f32_16x16x32_bf16 v[60:63], a[212:215], a[232:235], v[60:63]
  v_mfma_f32_16x16x32_bf16 v[56:59], a[192:195], a[248:251], v[56:59]
  v_mfma_f32_16x16x32_bf16 v[60:63], a[196:199], a[248:251], v[60:63]
  v_mfma_f32_16x16x32_bf16 v[56:59], a[216:219], a[224:227], v[56:59]
  v_mfma_f32_16x16x32_bf16 v[60:63], a[216:219], a[228:231], v[60:63]
  v_mfma_f32_16x16x32_bf16 v[60:63], a[192:195], a[252:255], v[60:63]
  v_mfma_f32_16x16x32_bf16 v[60:63], a[220:223], a[224:227], v[60:63]
  s_cmp_eq_u32 s79, 1
  s_cbranch_scc0 L_ow_15
  v_swap_b32 v32, v48
  v_swap_b32 v33, v49
  v_swap_b32 v34, v50
  v_swap_b32 v35, v51
  v_swap_b32 v36, v52
  v_swap_b32 v37, v53
  v_swap_b32 v38, v54
  v_swap_b32 v39, v55
  v_swap_b32 v40, v56
  v_swap_b32 v41, v57
  v_swap_b32 v42, v58
  v_swap_b32 v43, v59
  v_swap_b32 v44, v60
  v_swap_b32 v45, v61
  v_swap_b32 v46, v62
  v_swap_b32 v47, v63
L_ow_15:
  s_lshl_b32 s70, s66, 12
  s_add_u32 s70, s70, 52480
  v_add_u32 v24, s70, v4
  s_xor_b32 s71, s66, 1
  s_lshl_b32 s71, s71, 12
  s_add_u32 s71, s71, 52480
  v_add_u32 v13, s71, v4
  ds_write_b128 v24, v[48:51] offset:0
  ds_write_b128 v24, v[52:55] offset:1024
  ds_write_b128 v24, v[56:59] offset:2048
  ds_write_b128 v24, v[60:63] offset:3072
  s_lshr_b32 s70, s66, 1
  v_lshrrev_b32 v16, 1, v3
  v_lshl_add_u32 v16, v2, 1, v16
  v_and_b32 v18, 1, v3
  v_lshlrev_b32 v18, 3, v18
  s_lshl_b32 s71, s70, 4
  s_lshl_b32 s72, s79, 12
  s_add_u32 s71, s71, s72
  s_add_u32 s71, s71, 42496
  s_add_u32 s72, s72, 0
  v_add_u32 v19, s72, v4
  v_mov_b32 v30, v19
  v_lshl_add_u32 v17, v16, 5, v18
  v_add_u32 v17, s71, v17
  s_lshl_b32 s71, s79, 7
  s_sub_u32 s71, 159, s71
  v_sub_u32 v16, s71, v16
  v_bfe_u32 v19, v16, 3, 1
  v_xor_b32 v19, s70, v19
  v_lshlrev_b32 v16, 5, v16
  v_lshl_add_u32 v16, v19, 4, v16
  v_xor_b32 v18, 8, v18
  v_add_u32 v16, v16, v18
  ds_read_b64 v[88:89], v16 offset:36352
  ds_read_b64 v[90:91], v16 offset:35328
  ds_read_b64 v[92:93], v16 offset:34304
  ds_read_b64 v[94:95], v16 offset:33280
  ds_read_b64_tr_b16 v[232:233], v27 offset:0
  ds_read_b64_tr_b16 v[234:235], v27 offset:512
  ds_read_b64_tr_b16 v[236:237], v27 offset:4096
  ds_read_b64_tr_b16 v[238:239], v27 offset:4608
  s_lshl_b32 s70, s87, 14
  s_lshl_b32 s71, s64, 11
  s_add_u32 s70, s70, s71
  s_add_u32 s70, s70, 7340032
  s_cmp_lt_u32 s65, 28
  s_cselect_b32 s75, 0, 0x80000000
  s_add_u32 s70, s70, s75
  v_add_u32 v96, s70, v4
  s_lshr_b32 s70, s78, 1
  s_and_b32 s70, s70, 1
  s_lshr_b32 s71, s78, 2
  s_and_b32 s71, s71, 2
  s_or_b32 s70, s70, s71
  v_and_b32 v97, 3, v2
  v_xor_b32 v97, s70, v97
  v_lshlrev_b32 v97, 4, v97
  v_lshrrev_b32 v98, 1, v3
  v_lshl_add_u32 v97, v98, 6, v97
  v_lshrrev_b32 v98, 2, v2
  v_and_b32 v99, 1, v3
  v_lshl_add_u32 v98, v99, 2, v98
  v_lshl_add_u32 v97, v98, 16, v97
  s_lshl_b32 s70, s79, 20
  s_lshl_b32 s71, s78, 7
  s_add_u32 s70, s70, s71
  s_add_u32 s70, s70, 5242880
  v_add_u32 v97, s70, v97
  s_mul_i32 s70, s64, 14336
  s_lshl_b32 s71, s87, 7
  s_add_u32 s70, s70, s71
  s_add_u32 s70, s70, 655360
  s_add_u32 s70, s70, s75
  v_lshl_add_u32 v98, v1, 2, s70
  v_mov_b32 v76, 0x3f803f80
  v_mov_b32 v77, 0x3f803f80
  v_mov_b32 v78, 0x3f803f80
  v_mov_b32 v79, 0x3f803f80
  s_waitcnt lgkmcnt(0)
  v_lshlrev_b32 v115, 16, v88
  v_and_b32 v114, s69, v88
  v_lshlrev_b32 v113, 16, v89
  v_and_b32 v112, s69, v89
  v_lshlrev_b32 v119, 16, v90
  v_and_b32 v118, s69, v90
  v_lshlrev_b32 v117, 16, v91
  v_and_b32 v116, s69, v91
  v_lshlrev_b32 v123, 16, v92
  v_and_b32 v122, s69, v92
  v_lshlrev_b32 v121, 16, v93
  v_and_b32 v120, s69, v93
  v_lshlrev_b32 v127, 16, v94
  v_and_b32 v126, s69, v94
  v_lshlrev_b32 v125, 16, v95
  v_and_b32 v124, s69, v95
  v_lshlrev_b32 v160, 16, v232
  v_and_b32 v161, s69, v232
  v_lshlrev_b32 v162, 16, v233
  v_and_b32 v163, s69, v233
  v_lshlrev_b32 v164, 16, v234
  v_and_b32 v165, s69, v234
  v_lshlrev_b32 v166, 16, v235
  v_and_b32 v167, s69, v235
  v_lshlrev_b32 v168, 16, v236
  v_and_b32 v169, s69, v236
  v_lshlrev_b32 v170, 16, v237
  v_and_b32 v171, s69, v237
  v_lshlrev_b32 v172, 16, v238
  v_and_b32 v173, s69, v238
  v_lshlrev_b32 v174, 16, v239
  v_and_b32 v175, s69, v239
  v_lshlrev_b32 v75, 16, v75
  v_pk_fma_f32 v[32:33], v[112:113], v[74:75], v[32:33] op_sel:[0,1,0] op_sel_hi:[1,1,1]
  v_pk_fma_f32 v[34:35], v[114:115], v[74:75], v[34:35] op_sel:[0,1,0] op_sel_hi:[1,1,1]
  v_pk_fma_f32 v[36:37], v[116:117], v[74:75], v[36:37] op_sel:[0,1,0] op_sel_hi:[1,1,1]
  v_pk_fma_f32 v[38:39], v[118:119], v[74:75], v[38:39] op_sel:[0,1,0] op_sel_hi:[1,1,1]
  v_pk_fma_f32 v[40:41], v[120:121], v[74:75], v[40:41] op_sel:[0,1,0] op_sel_hi:[1,1,1]
  v_pk_fma_f32 v[42:43], v[122:123], v[74:75], v[42:43] op_sel:[0,1,0] op_sel_hi:[1,1,1]
  v_pk_fma_f32 v[44:45], v[124:125], v[74:75], v[44:45] op_sel:[0,1,0] op_sel_hi:[1,1,1]
  v_pk_fma_f32 v[46:47], v[126:127], v[74:75], v[46:47] op_sel:[0,1,0] op_sel_hi:[1,1,1]
  s_cmp_eq_u32 s66, 0
  s_cbranch_scc0 L_ow_16
  s_mov_b32 s77, 0
  s_mov_b64 exec, 0xffff
  s_branch L_pollc_19
L_poll_17:
  buffer_load_dword v31, v26, s[60:63], 0 offen offset:128 sc1
L_pollc_19:
  s_waitcnt vmcnt(0)
  v_cmp_gt_u32 vcc, 1, v31
  s_nop 0
  s_cbranch_vccz L_polld_18
  s_sleep 1
  s_add_u32 s77, s77, 1
  s_cmp_lt_u32 s77, 200000
  s_cbranch_scc1 L_poll_17
L_polld_18:
  s_mov_b64 exec, -1
L_ow_16:
  v_cmp_eq_u32 vcc, 1, v3
  s_waitcnt lgkmcnt(0)
  s_barrier
  s_mov_b32 s73, 0
  buffer_load_dword v208, v20, s[60:63], s73 offen sc1
  buffer_load_dword v212, v20, s[60:63], s73 offen offset:2048 sc1
  s_mov_b32 s73, 12288
  buffer_load_dword v209, v20, s[60:63], s73 offen sc1
  buffer_load_dword v213, v20, s[60:63], s73 offen offset:2048 sc1
  s_mov_b32 s73, 24576
  buffer_load_dword v210, v20, s[60:63], s73 offen sc1
  buffer_load_dword v214, v20, s[60:63], s73 offen offset:2048 sc1
  s_mov_b32 s73, 36864
  buffer_load_dword v211, v20, s[60:63], s73 offen sc1
  buffer_load_dword v215, v20, s[60:63], s73 offen offset:2048 sc1
  buffer_load_dword v72, v23, s[60:63], 0 offen sc1
  s_lshl_b32 s72, s66, 11
  s_add_u32 m0, s72, 42496
  s_lshl_b32 s73, s66, 16
  s_add_u32 s73, s73, 2097152
  buffer_load_dwordx4 v25, s[60:63], s73 offen sc1 lds
  s_lshl_b32 s72, s66, 11
  s_add_u32 m0, s72, 43520
  s_lshl_b32 s73, s66, 16
  s_add_u32 s73, s73, 2129920
  buffer_load_dwordx4 v25, s[60:63], s73 offen sc1 lds
  s_lshl_b32 s72, s66, 12
  s_add_u32 m0, s72, 0
  s_nop 0
  buffer_load_dwordx4 v22, s[60:63], 0 offen offset:0 sc1 lds
  s_lshl_b32 s72, s66, 12
  s_add_u32 m0, s72, 0
  s_nop 0
  buffer_load_dwordx4 v22, s[60:63], 0 offen offset:1024 sc1 lds
  s_lshl_b32 s72, s66, 12
  s_add_u32 m0, s72, 0
  s_nop 0
  buffer_load_dwordx4 v22, s[60:63], 0 offen offset:2048 sc1 lds
  s_lshl_b32 s72, s66, 12
  s_add_u32 m0, s72, 0
  s_nop 0
  buffer_load_dwordx4 v22, s[60:63], 0 offen offset:3072 sc1 lds
  ds_read_b128 v[176:179], v13 offset:0
  ds_read_b128 v[180:183], v13 offset:1024
  ds_read_b128 v[184:187], v13 offset:2048
  ds_read_b128 v[188:191], v13 offset:3072
  s_waitcnt lgkmcnt(0)
  v_pk_add_f32 v[32:33], v[32:33], v[176:177]
  v_pk_add_f32 v[34:35], v[34:35], v[178:179]
  v_pk_add_f32 v[36:37], v[36:37], v[180:181]
  v_pk_add_f32 v[38:39], v[38:39], v[182:183]
  v_pk_add_f32 v[40:41], v[40:41], v[184:185]
  v_pk_add_f32 v[42:43], v[42:43], v[186:187]
  v_pk_add_f32 v[44:45], v[44:45], v[188:189]
  v_pk_add_f32 v[46:47], v[46:47], v[190:191]
  s_waitcnt vmcnt(6)
  v_add_f32 v208, v208, v209
  v_add_f32 v212, v212, v213
  v_add_f32 v210, v210, v211
  v_add_f32 v214, v214, v215
  v_add_f32 v208, v208, v210
  v_add_f32 v212, v212, v214
  v_cvt_pk_bf16_f32 v208, v208, v212
  v_and_b32 v212, s69, v208
  v_add_f32 v212, 1.0, v212
  v_cvt_pk_bf16_f32 v212, v212, v212
  v_and_b32 v212, s69, v212
  ds_write_b16 v15, v208 offset:256
  ds_write_b32 v21, v212
  s_waitcnt lgkmcnt(0)
  ds_read_b128 v[208:211], v28 offset:0
  ds_read_b128 v[212:215], v28 offset:16
  ds_read_b128 v[216:219], v28 offset:128
  ds_read_b128 v[220:223], v28 offset:144
  ds_read_b128 v[224:227], v29 offset:256
  ds_read_b128 v[228:231], v29 offset:320
  s_waitcnt lgkmcnt(4)
  v_pk_mul_f32 v[160:161], v[160:161], v[208:209]
  v_pk_mul_f32 v[162:163], v[162:163], v[210:211]
  v_pk_mul_f32 v[164:165], v[164:165], v[212:213]
  v_pk_mul_f32 v[166:167], v[166:167], v[214:215]
  v_cvt_pk_bf16_f32 v64, v160, v161
  v_cvt_pk_bf16_f32 v65, v162, v163
  v_cvt_pk_bf16_f32 v66, v164, v165
  v_cvt_pk_bf16_f32 v67, v166, v167
  buffer_store_dwordx4 v[64:67], v96, s[60:63], 0 offen offset:0 sc1
  s_waitcnt lgkmcnt(2)
  v_pk_mul_f32 v[168:169], v[168:169], v[216:217]
  v_pk_mul_f32 v[170:171], v[170:171], v[218:219]
  v_pk_mul_f32 v[172:173], v[172:173], v[220:221]
  v_pk_mul_f32 v[174:175], v[174:175], v[222:223]
  v_cvt_pk_bf16_f32 v68, v168, v169
  v_cvt_pk_bf16_f32 v69, v170, v171
  v_cvt_pk_bf16_f32 v70, v172, v173
  v_cvt_pk_bf16_f32 v71, v174, v175
  buffer_store_dwordx4 v[68:71], v96, s[60:63], 0 offen offset:1024 sc1
  s_waitcnt lgkmcnt(0)
  v_mfma_f32_16x16x32_bf16 v[80:83], v[76:79], v[64:67], 0
  v_mfma_f32_16x16x32_bf16 v[84:87], v[224:227], v[232:235], 0
  v_mfma_f32_16x16x32_bf16 v[80:83], v[76:79], v[68:71], v[80:83]
  v_mfma_f32_16x16x32_bf16 v[84:87], v[228:231], v[236:239], v[84:87]
  s_waitcnt vmcnt(2)
  s_barrier
  ds_read_b128 v[240:243], v30 offset:0
  ds_read_b128 v[144:147], v30 offset:8192
  ds_read_b128 v[244:247], v30 offset:1024
  ds_read_b128 v[148:151], v30 offset:9216
  ds_read_b128 v[248:251], v30 offset:2048
  ds_read_b128 v[152:155], v30 offset:10240
  ds_read_b128 v[252:255], v30 offset:3072
  ds_read_b128 v[156:159], v30 offset:11264
  ds_read_b64 v[104:105], v17 offset:0
  ds_read_b64 v[106:107], v17 offset:1024
  ds_read_b64 v[108:109], v17 offset:2048
  ds_read_b64 v[110:111], v17 offset:3072
  v_add_f32_dpp v72, v72, v72 quad_perm:[1,0,3,2] row_mask:0xf bank_mask:0xf
  s_mov_b32 s73, 524288
  s_nop 0
  v_add_f32_dpp v72, v72, v72 quad_perm:[2,3,0,1] row_mask:0xf bank_mask:0xf
  v_cvt_pk_bf16_f32 v72, v72, v72
  v_and_b32 v72, s69, v72
  v_add_f32 v73, 1.0, v72
  v_cvt_pk_bf16_f32 v73, v73, v73
  v_and_b32 v73, s69, v73
  v_readlane_b32 s70, v72, 0
  v_readlane_b32 s72, v72, 8
  v_readlane_b32 s71, v73, 4
  s_nop 0
  v_mov_b32 v74, s72
  v_mul_f32 v72, s70, v74
  v_mul_f32 v73, s71, v74
  s_waitcnt lgkmcnt(0)
  v_lshlrev_b32 v128, 16, v104
  v_and_b32 v129, s69, v104
  v_lshlrev_b32 v130, 16, v105
  v_and_b32 v131, s69, v105
  v_lshlrev_b32 v132, 16, v106
  v_and_b32 v133, s69, v106
  v_lshlrev_b32 v134, 16, v107
  v_and_b32 v135, s69, v107
  v_lshlrev_b32 v136, 16, v108
  v_and_b32 v137, s69, v108
  v_lshlrev_b32 v138, 16, v109
  v_and_b32 v139, s69, v109
  v_lshlrev_b32 v140, 16, v110
  v_and_b32 v141, s69, v110
  v_lshlrev_b32 v142, 16, v111
  v_and_b32 v143, s69, v111
  v_pk_fma_f32 v[240:241], v[128:129], v[240:241], v[144:145]
  v_pk_fma_f32 v[242:243], v[130:131], v[242:243], v[146:147]
  v_pk_fma_f32 v[244:245], v[132:133], v[244:245], v[148:149]
  v_pk_fma_f32 v[246:247], v[134:135], v[246:247], v[150:151]
  v_pk_fma_f32 v[240:241], v[240:241], v[72:73], v[72:73] op_sel:[0,1,0] op_sel_hi:[1,1,0]
  v_pk_fma_f32 v[242:243], v[242:243], v[72:73], v[72:73] op_sel:[0,1,0] op_sel_hi:[1,1,0]
  v_pk_fma_f32 v[244:245], v[244:245], v[72:73], v[72:73] op_sel:[0,1,0] op_sel_hi:[1,1,0]
  v_pk_fma_f32 v[246:247], v[246:247], v[72:73], v[72:73] op_sel:[0,1,0] op_sel_hi:[1,1,0]
  v_pk_fma_f32 v[32:33], v[32:33], v[240:241], v[128:129]
  v_pk_fma_f32 v[34:35], v[34:35], v[242:243], v[130:131]
  v_pk_fma_f32 v[36:37], v[36:37], v[244:245], v[132:133]
  v_pk_fma_f32 v[38:39], v[38:39], v[246:247], v[134:135]
  v_cvt_pk_bf16_f32 v88, v32, v33
  v_cvt_pk_bf16_f32 v89, v34, v35
  v_cvt_pk_bf16_f32 v90, v36, v37
  v_cvt_pk_bf16_f32 v91, v38, v39
  s_nop 0
  v_permlane16_swap_b32 v88, v90
  v_permlane16_swap_b32 v89, v91
  buffer_store_dwordx4 v[88:91], v97, s[60:63], 0 offen sc1
  v_pk_fma_f32 v[248:249], v[136:137], v[248:249], v[152:153]
  v_pk_fma_f32 v[250:251], v[138:139], v[250:251], v[154:155]
  v_pk_fma_f32 v[252:253], v[140:141], v[252:253], v[156:157]
  v_pk_fma_f32 v[254:255], v[142:143], v[254:255], v[158:159]
  v_pk_fma_f32 v[248:249], v[248:249], v[72:73], v[72:73] op_sel:[0,1,0] op_sel_hi:[1,1,0]
  v_pk_fma_f32 v[250:251], v[250:251], v[72:73], v[72:73] op_sel:[0,1,0] op_sel_hi:[1,1,0]
  v_pk_fma_f32 v[252:253], v[252:253], v[72:73], v[72:73] op_sel:[0,1,0] op_sel_hi:[1,1,0]
  v_pk_fma_f32 v[254:255], v[254:255], v[72:73], v[72:73] op_sel:[0,1,0] op_sel_hi:[1,1,0]
  v_pk_fma_f32 v[40:41], v[40:41], v[248:249], v[136:137]
  v_pk_fma_f32 v[42:43], v[42:43], v[250:251], v[138:139]
  v_pk_fma_f32 v[44:45], v[44:45], v[252:253], v[140:141]
  v_pk_fma_f32 v[46:47], v[46:47], v[254:255], v[142:143]
  v_cvt_pk_bf16_f32 v92, v40, v41
  v_cvt_pk_bf16_f32 v93, v42, v43
  v_cvt_pk_bf16_f32 v94, v44, v45
  v_cvt_pk_bf16_f32 v95, v46, v47
  s_nop 0
  v_permlane16_swap_b32 v92, v94
  v_permlane16_swap_b32 v93, v95
  buffer_store_dwordx4 v[92:95], v97, s[60:63], s73 offen sc1
  v_cndmask_b32 v80, v80, v84, vcc
  s_mov_b32 exec_hi, 0
  buffer_store_dword v80, v98, s[60:63], 0 offen sc1
  s_mov_b64 exec, -1
  s_waitcnt vmcnt(0)
  s_waitcnt lgkmcnt(0)
  s_barrier
  s_cmp_eq_u32 s66, 0
  s_cbranch_scc0 L_ow_20
  s_lshl_b32 s70, s64, 1
  s_lshr_b32 s71, s2, 7
  s_add_u32 s70, s70, s71
  s_lshl_b32 s70, s70, 8
  s_add_u32 s70, s70, 4096
  v_mov_b32 v72, s70
  v_mov_b32 v73, 1
  s_mov_b64 exec, 1
  buffer_atomic_add v73, v72, s[60:63], 0 offen sc0 sc1
  s_mov_b64 exec, -1
  s_waitcnt vmcnt(0)
  v_readfirstlane_b32 s70, v73
  s_nop 0
  s_cmp_lg_u32 s70, 15
  s_cbranch_scc1 L_af_21
  s_mov_b64 exec, 1
  buffer_store_dword v73, v72, s[60:63], 0 offen offset:128 sc1
  s_mov_b64 exec, -1
L_af_21:
L_ow_20:
  ds_read_b128 a[0:3], v10 offset:0
  ds_read_b128 a[4:7], v10 offset:2048
  ds_read_b128 a[8:11], v10 offset:4096
  ds_read_b128 a[12:15], v10 offset:6144
  ds_read_b128 a[16:19], v11 offset:0
  ds_read_b128 a[20:23], v11 offset:2048
  ds_read_b128 a[24:27], v11 offset:4096
  ds_read_b128 a[28:31], v11 offset:6144
  ds_read_b128 a[32:35], v10 offset:8192
  ds_read_b128 a[36:39], v10 offset:10240
  ds_read_b128 a[40:43], v10 offset:12288
  ds_read_b128 a[44:47], v10 offset:14336
  ds_read_b128 a[48:51], v11 offset:8192
  ds_read_b128 a[52:55], v11 offset:10240
  ds_read_b128 a[56:59], v11 offset:12288
  ds_read_b128 a[60:63], v11 offset:14336
  s_mul_i32 s87, s68, 7
  s_lshl_b32 s70, s66, 1
  s_add_u32 s87, s87, s70
  s_cmp_eq_u32 s66, 3
  s_cselect_b32 s88, 0x80000000, 0
  s_lshl_b32 s70, s87, 14
  s_add_u32 s70, s70, 8257536
  v_add_u32 v16, s70, v4
  s_add_u32 s70, s70, 16384
  s_add_u32 s70, s70, s88
  v_add_u32 v17, s70, v4
  s_mov_b32 s89, 4096
  s_mov_b32 s90, 8192
  s_mov_b32 s91, 12288
  s_waitcnt lgkmcnt(0)
  s_add_u32 m0, s84, 8192
  s_add_u32 s74, s85, 256
  s_and_b32 s74, s74, 0x3ff
  v_add_u32 v12, s74, v8
  buffer_load_dwordx4 v12, s[32:35], s80 offen lds
  s_add_u32 m0, m0, 1024
  s_nop 0
  buffer_load_dwordx4 v12, s[32:35], s4 offen lds
  s_add_u32 m0, m0, 1024
  s_nop 0
  buffer_load_dwordx4 v12, s[32:35], s81 offen lds
  s_add_u32 m0, m0, 1024
  s_nop 0
  buffer_load_dwordx4 v12, s[32:35], s5 offen lds
  s_add_u32 m0, m0, 1024
  s_nop 0
  buffer_load_dwordx4 v12, s[32:35], s82 offen lds
  s_add_u32 m0, m0, 1024
  s_nop 0
  buffer_load_dwordx4 v12, s[32:35], s6 offen lds
  s_add_u32 m0, m0, 1024
  s_nop 0
  buffer_load_dwordx4 v12, s[32:35], s83 offen lds
  s_add_u32 m0, m0, 1024
  s_nop 0
  buffer_load_dwordx4 v12, s[32:35], s7 offen lds
  v_lshrrev_b32 v72, 2, v2
  v_lshl_add_u32 v72, v3, 3, v72
  v_lshlrev_b32 v72, 7, v72
  v_and_b32 v73, 1, v2
  v_lshl_add_u32 v72, v73, 3, v72
  v_bfe_u32 v73, v2, 1, 1
  v_lshl_add_u32 v72, v73, 6, v72
  v_lshrrev_b32 v73, 3, v2
  v_and_b32 v74, 1, v3
  v_lshl_or_b32 v73, v74, 1, v73
  v_mov_b32 v26, 0x3f803f80
  v_mov_b32 v27, 0x3f803f80
  v_mov_b32 v28, 0x3f803f80
  v_mov_b32 v29, 0x3f803f80
  v_mov_b32 v14, 0xc0135761
  v_mov_b32 v15, 0xbdd2d3e8
  s_add_u32 s70, s66, 0
  s_and_b32 s70, s70, 3
  v_xor_b32 v74, s70, v73
  v_lshl_add_u32 v18, v74, 4, v72
  s_lshl_b32 s70, s70, 7
  s_add_u32 s70, s70, 155648
  v_lshl_add_u32 v22, v2, 3, s70
  s_add_u32 s70, s66, 1
  s_and_b32 s70, s70, 3
  v_xor_b32 v74, s70, v73
  v_lshl_add_u32 v19, v74, 4, v72
  s_lshl_b32 s70, s70, 7
  s_add_u32 s70, s70, 155648
  v_lshl_add_u32 v23, v2, 3, s70
  s_add_u32 s70, s66, 2
  s_and_b32 s70, s70, 3
  v_xor_b32 v74, s70, v73
  v_lshl_add_u32 v20, v74, 4, v72
  s_lshl_b32 s70, s70, 7
  s_add_u32 s70, s70, 155648
  v_lshl_add_u32 v24, v2, 3, s70
  s_add_u32 s70, s66, 3
  s_and_b32 s70, s70, 3
  v_xor_b32 v74, s70, v73
  v_lshl_add_u32 v21, v74, 4, v72
  s_lshl_b32 s70, s70, 7
  s_add_u32 s70, s70, 155648
  v_lshl_add_u32 v25, v2, 3, s70
  s_lshl_b32 s70, s67, 16
  s_lshl_b32 s71, s66, 10
  s_add_u32 s70, s70, s71
  s_add_u32 s70, s70, 5242880
  v_add_u32 v30, s70, v4
  s_mov_b32 s92, s71
  s_lshl_b32 s70, s87, 7
  s_add_u32 s70, s70, 655360
  v_lshl_add_u32 v31, v1, 2, s70
  s_waitcnt lgkmcnt(0)
  s_add_u32 m0, s84, 0
  s_add_u32 s74, s85, 512
  s_and_b32 s74, s74, 0x3ff
  v_add_u32 v12, s74, v8
  buffer_load_dwordx4 v12, s[32:35], s80 offen lds
  s_add_u32 m0, m0, 1024
  s_nop 0
  buffer_load_dwordx4 v12, s[32:35], s4 offen lds
  s_add_u32 m0, m0, 1024
  s_nop 0
  buffer_load_dwordx4 v12, s[32:35], s81 offen lds
  s_add_u32 m0, m0, 1024
  s_nop 0
  buffer_load_dwordx4 v12, s[32:35], s5 offen lds
  s_add_u32 m0, m0, 1024
  s_nop 0
  buffer_load_dwordx4 v12, s[32:35], s82 offen lds
  s_add_u32 m0, m0, 1024
  s_nop 0
  buffer_load_dwordx4 v12, s[32:35], s6 offen lds
  s_add_u32 m0, m0, 1024
  s_nop 0
  buffer_load_dwordx4 v12, s[32:35], s83 offen lds
  s_add_u32 m0, m0, 1024
  s_nop 0
  buffer_load_dwordx4 v12, s[32:35], s7 offen lds
  s_waitcnt vmcnt(8)
  ds_read_b128 a[64:67], v10 offset:8192
  ds_read_b128 a[68:71], v10 offset:10240
  ds_read_b128 a[72:75], v10 offset:12288
  ds_read_b128 a[76:79], v10 offset:14336
  ds_read_b128 a[80:83], v11 offset:8192
  ds_read_b128 a[84:87], v11 offset:10240
  ds_read_b128 a[88:91], v11 offset:12288
  ds_read_b128 a[92:95], v11 offset:14336
  s_waitcnt lgkmcnt(0)
  s_add_u32 m0, s84, 8192
  s_add_u32 s74, s85, 768
  s_and_b32 s74, s74, 0x3ff
  v_add_u32 v12, s74, v8
  buffer_load_dwordx4 v12, s[32:35], s80 offen lds
  s_add_u32 m0, m0, 1024
  s_nop 0
  buffer_load_dwordx4 v12, s[32:35], s4 offen lds
  s_add_u32 m0, m0, 1024
  s_nop 0
  buffer_load_dwordx4 v12, s[32:35], s81 offen lds
  s_add_u32 m0, m0, 1024
  s_nop 0
  buffer_load_dwordx4 v12, s[32:35], s5 offen lds
  s_add_u32 m0, m0, 1024
  s_nop 0
  buffer_load_dwordx4 v12, s[32:35], s82 offen lds
  s_add_u32 m0, m0, 1024
  s_nop 0
  buffer_load_dwordx4 v12, s[32:35], s6 offen lds
  s_add_u32 m0, m0, 1024
  s_nop 0
  buffer_load_dwordx4 v12, s[32:35], s83 offen lds
  s_add_u32 m0, m0, 1024
  s_nop 0
  buffer_load_dwordx4 v12, s[32:35], s7 offen lds
  s_cmp_eq_u32 s66, 0
  s_cbranch_scc0 L_ow_22
  v_lshlrev_b32 v72, 8, v2
  v_add_u32 v72, 4096, v72
  s_mov_b32 s77, 0
  s_mov_b64 exec, 0xffff
L_poll_23:
  buffer_load_dword v73, v72, s[60:63], 0 offen offset:128 sc1
  s_waitcnt vmcnt(0)
  v_cmp_gt_u32 vcc, 1, v73
  s_nop 0
  s_cbranch_vccz L_polld_24
  s_sleep 1
  s_add_u32 s77, s77, 1
  s_cmp_lt_u32 s77, 200000
  s_cbranch_scc1 L_poll_23
L_polld_24:
  s_mov_b64 exec, -1
L_ow_22:
  s_waitcnt vmcnt(0)
  ds_read_b128 a[192:195], v10 offset:8192
  ds_read_b128 a[196:199], v10 offset:10240
  ds_read_b128 a[200:203], v10 offset:12288
  ds_read_b128 a[204:207], v10 offset:14336
  ds_read_b128 a[208:211], v11 offset:8192
  ds_read_b128 a[212:215], v11 offset:10240
  ds_read_b128 a[216:219], v11 offset:12288
  ds_read_b128 a[220:223], v11 offset:14336
  ds_read_b128 a[128:131], v10 offset:0
  ds_read_b128 a[132:135], v10 offset:2048
  ds_read_b128 a[136:139], v10 offset:4096
  ds_read_b128 a[140:143], v10 offset:6144
  ds_read_b128 a[144:147], v11 offset:0
  ds_read_b128 a[148:151], v11 offset:2048
  ds_read_b128 a[152:155], v11 offset:4096
  ds_read_b128 a[156:159], v11 offset:6144
  s_barrier
  s_add_u32 m0, s92, 0
  s_mov_b32 s70, 0
  buffer_load_dwordx4 v30, s[60:63], s70 offen sc1 lds
  s_add_u32 m0, s92, 4096
  s_mov_b32 s70, 4096
  buffer_load_dwordx4 v30, s[60:63], s70 offen sc1 lds
  s_add_u32 m0, s92, 8192
  s_mov_b32 s70, 8192
  buffer_load_dwordx4 v30, s[60:63], s70 offen sc1 lds
  s_add_u32 m0, s92, 12288
  s_mov_b32 s70, 12288
  buffer_load_dwordx4 v30, s[60:63], s70 offen sc1 lds
  buffer_load_dwordx4 v[128:131], v16, s[60:63], 0 offen offset:0 sc1
  buffer_load_dwordx4 v[192:195], v17, s[60:63], 0 offen offset:0 sc1
  buffer_load_dwordx4 v[132:135], v16, s[60:63], 0 offen offset:1024 sc1
  buffer_load_dwordx4 v[196:199], v17, s[60:63], 0 offen offset:1024 sc1
  s_add_u32 m0, s92, 16384
  s_mov_b32 s70, 16384
  buffer_load_dwordx4 v30, s[60:63], s70 offen sc1 lds
  s_add_u32 m0, s92, 20480
  s_mov_b32 s70, 20480
  buffer_load_dwordx4 v30, s[60:63], s70 offen sc1 lds
  s_add_u32 m0, s92, 24576
  s_mov_b32 s70, 24576
  buffer_load_dwordx4 v30, s[60:63], s70 offen sc1 lds
  s_add_u32 m0, s92, 28672
  s_mov_b32 s70, 28672
  buffer_load_dwordx4 v30, s[60:63], s70 offen sc1 lds
  buffer_load_dwordx4 v[136:139], v16, s[60:63], 0 offen offset:2048 sc1
  buffer_load_dwordx4 v[200:203], v17, s[60:63], 0 offen offset:2048 sc1
  buffer_load_dwordx4 v[140:143], v16, s[60:63], 0 offen offset:3072 sc1
  buffer_load_dwordx4 v[204:207], v17, s[60:63], 0 offen offset:3072 sc1
  s_waitcnt vmcnt(12)
  s_waitcnt lgkmcnt(0)
  s_barrier
  ds_read_b64_tr_b16 v[64:65], v18 offset:0
  ds_read_b64_tr_b16 v[66:67], v18 offset:512
  ds_read_b64_tr_b16 v[68:69], v19 offset:0
  ds_read_b64_tr_b16 v[70:71], v19 offset:512
  ds_read_b64_tr_b16 v[72:73], v20 offset:0
  ds_read_b64_tr_b16 v[74:75], v20 offset:512
  ds_read_b64_tr_b16 v[76:77], v21 offset:0
  ds_read_b64_tr_b16 v[78:79], v21 offset:512
  ds_read_b64_tr_b16 v[80:81], v18 offset:4096
  ds_read_b64_tr_b16 v[82:83], v18 offset:4608
  ds_read_b64_tr_b16 v[84:85], v19 offset:4096
  ds_read_b64_tr_b16 v[86:87], v19 offset:4608
  ds_read_b64_tr_b16 v[88:89], v20 offset:4096
  ds_read_b64_tr_b16 v[90:91], v20 offset:4608
  ds_read_b64_tr_b16 v[92:93], v21 offset:4096
  ds_read_b64_tr_b16 v[94:95], v21 offset:4608
  s_waitcnt lgkmcnt(8)
  s_waitcnt vmcnt(10)
  v_mfma_f32_16x16x32_bf16 a[240:243], v[26:29], v[64:67], 0
  v_mfma_f32_16x16x32_bf16 a[244:247], v[64:67], v[64:67], 0
  v_mfma_f32_16x16x32_bf16 v[32:35], v[128:131], v[64:67], 0
  ds_read_b64_tr_b16 v[96:97], v18 offset:8192
  v_mfma_f32_16x16x32_bf16 v[36:39], v[128:131], v[68:71], 0
  ds_read_b64_tr_b16 v[98:99], v18 offset:8704
  buffer_load_dwordx4 v[144:147], v16, s[60:63], s89 offen offset:0 sc1
  v_mfma_f32_16x16x32_bf16 v[40:43], v[128:131], v[72:75], 0
  ds_read_b64_tr_b16 v[100:101], v19 offset:8192
  v_mfma_f32_16x16x32_bf16 v[44:47], v[128:131], v[76:79], 0
  ds_read_b64_tr_b16 v[102:103], v19 offset:8704
  buffer_load_dwordx4 v[208:211], v17, s[60:63], s89 offen offset:0 sc1
  v_mfma_f32_16x16x32_bf16 v[48:51], v[192:195], v[64:67], 0
  ds_read_b64_tr_b16 v[104:105], v20 offset:8192
  v_mfma_f32_16x16x32_bf16 v[52:55], v[192:195], v[68:71], 0
  ds_read_b64_tr_b16 v[106:107], v20 offset:8704
  s_add_u32 m0, s92, 32768
  s_mov_b32 s70, 32768
  buffer_load_dwordx4 v30, s[60:63], s70 offen sc1 lds
  v_mfma_f32_16x16x32_bf16 v[56:59], v[192:195], v[72:75], 0
  ds_read_b64_tr_b16 v[108:109], v21 offset:8192
  v_mfma_f32_16x16x32_bf16 v[60:63], v[192:195], v[76:79], 0
  ds_read_b64_tr_b16 v[110:111], v21 offset:8704
  s_add_u32 m0, s92, 36864
  s_mov_b32 s70, 36864
  buffer_load_dwordx4 v30, s[60:63], s70 offen sc1 lds
  s_waitcnt lgkmcnt(8)
  s_waitcnt vmcnt(12)
  v_mfma_f32_16x16x32_bf16 a[240:243], v[26:29], v[80:83], a[240:243]
  v_mfma_f32_16x16x32_bf16 a[244:247], v[80:83], v[80:83], a[244:247]
  v_mfma_f32_16x16x32_bf16 v[32:35], v[132:135], v[80:83], v[32:35]
  ds_read_b64_tr_b16 v[64:65], v18 offset:12288
  v_mfma_f32_16x16x32_bf16 v[36:39], v[132:135], v[84:87], v[36:39]
  ds_read_b64_tr_b16 v[66:67], v18 offset:12800
  buffer_load_dwordx4 v[148:151], v16, s[60:63], s89 offen offset:1024 sc1
  v_mfma_f32_16x16x32_bf16 v[40:43], v[132:135], v[88:91], v[40:43]
  ds_read_b64_tr_b16 v[68:69], v19 offset:12288
  v_mfma_f32_16x16x32_bf16 v[44:47], v[132:135], v[92:95], v[44:47]
  ds_read_b64_tr_b16 v[70:71], v19 offset:12800
  buffer_load_dwordx4 v[212:215], v17, s[60:63], s89 offen offset:1024 sc1
  v_mfma_f32_16x16x32_bf16 v[48:51], v[196:199], v[80:83], v[48:51]
  ds_read_b64_tr_b16 v[72:73], v20 offset:12288
  v_mfma_f32_16x16x32_bf16 v[52:55], v[196:199], v[84:87], v[52:55]
  ds_read_b64_tr_b16 v[74:75], v20 offset:12800
  s_add_u32 m0, s92, 40960
  s_mov_b32 s70, 40960
  buffer_load_dwordx4 v30, s[60:63], s70 offen sc1 lds
  v_mfma_f32_16x16x32_bf16 v[56:59], v[196:199], v[88:91], v[56:59]
  ds_read_b64_tr_b16 v[76:77], v21 offset:12288
  v_mfma_f32_16x16x32_bf16 v[60:63], v[196:199], v[92:95], v[60:63]
  ds_read_b64_tr_b16 v[78:79], v21 offset:12800
  s_add_u32 m0, s92, 45056
  s_mov_b32 s70, 45056
  buffer_load_dwordx4 v30, s[60:63], s70 offen sc1 lds
  s_waitcnt vmcnt(12)
  s_barrier
  s_waitcnt lgkmcnt(8)
  s_waitcnt vmcnt(10)
  v_mfma_f32_16x16x32_bf16 a[240:243], v[26:29], v[96:99], a[240:243]
  v_mfma_f32_16x16x32_bf16 a[244:247], v[96:99], v[96:99], a[244:247]
  v_mfma_f32_16x16x32_bf16 v[32:35], v[136:139], v[96:99], v[32:35]
  ds_read_b64_tr_b16 v[80:81], v18 offset:16384
  v_mfma_f32_16x16x32_bf16 v[36:39], v[136:139], v[100:103], v[36:39]
  ds_read_b64_tr_b16 v[82:83], v18 offset:16896
  buffer_load_dwordx4 v[152:155], v16, s[60:63], s89 offen offset:2048 sc1
  v_mfma_f32_16x16x32_bf16 v[40:43], v[136:139], v[104:107], v[40:43]
  ds_read_b64_tr_b16 v[84:85], v19 offset:16384
  v_mfma_f32_16x16x32_bf16 v[44:47], v[136:139], v[108:111], v[44:47]
  ds_read_b64_tr_b16 v[86:87], v19 offset:16896
  buffer_load_dwordx4 v[216:219], v17, s[60:63], s89 offen offset:2048 sc1
  v_mfma_f32_16x16x32_bf16 v[48:51], v[200:203], v[96:99], v[48:51]
  ds_read_b64_tr_b16 v[88:89], v20 offset:16384
  v_mfma_f32_16x16x32_bf16 v[52:55], v[200:203], v[100:103], v[52:55]
  ds_read_b64_tr_b16 v[90:91], v20 offset:16896
  buffer_load_dwordx4 v[156:159], v16, s[60:63], s89 offen offset:3072 sc1
  v_mfma_f32_16x16x32_bf16 v[56:59], v[200:203], v[104:107], v[56:59]
  ds_read_b64_tr_b16 v[92:93], v21 offset:16384
  v_mfma_f32_16x16x32_bf16 v[60:63], v[200:203], v[108:111], v[60:63]
  ds_read_b64_tr_b16 v[94:95], v21 offset:16896
  buffer_load_dwordx4 v[220:223], v17, s[60:63], s89 offen offset:3072 sc1
  s_waitcnt lgkmcnt(8)
  s_waitcnt vmcnt(12)
  v_mfma_f32_16x16x32_bf16 a[240:243], v[26:29], v[64:67], a[240:243]
  v_mfma_f32_16x16x32_bf16 a[244:247], v[64:67], v[64:67], a[244:247]
  v_mfma_f32_16x16x32_bf16 v[32:35], v[140:143], v[64:67], v[32:35]
  ds_read_b64_tr_b16 v[96:97], v18 offset:20480
  v_mfma_f32_16x16x32_bf16 v[36:39], v[140:143], v[68:71], v[36:39]
  ds_read_b64_tr_b16 v[98:99], v18 offset:20992
  s_add_u32 m0, s92, 49152
  s_mov_b32 s70, 49152
  buffer_load_dwordx4 v30, s[60:63], s70 offen sc1 lds
  v_mfma_f32_16x16x32_bf16 v[40:43], v[140:143], v[72:75], v[40:43]
  ds_read_b64_tr_b16 v[100:101], v19 offset:20480
  v_mfma_f32_16x16x32_bf16 v[44:47], v[140:143], v[76:79], v[44:47]
  ds_read_b64_tr_b16 v[102:103], v19 offset:20992
  s_add_u32 m0, s92, 53248
  s_mov_b32 s70, 53248
  buffer_load_dwordx4 v30, s[60:63], s70 offen sc1 lds
  v_mfma_f32_16x16x32_bf16 v[48:51], v[204:207], v[64:67], v[48:51]
  ds_read_b64_tr_b16 v[104:105], v20 offset:20480
  v_mfma_f32_16x16x32_bf16 v[52:55], v[204:207], v[68:71], v[52:55]
  ds_read_b64_tr_b16 v[106:107], v20 offset:20992
  buffer_load_dwordx4 v[160:163], v16, s[60:63], s90 offen offset:0 sc1
  v_mfma_f32_16x16x32_bf16 v[56:59], v[204:207], v[72:75], v[56:59]
  ds_read_b64_tr_b16 v[108:109], v21 offset:20480
  v_mfma_f32_16x16x32_bf16 v[60:63], v[204:207], v[76:79], v[60:63]
  ds_read_b64_tr_b16 v[110:111], v21 offset:20992
  buffer_load_dwordx4 v[224:227], v17, s[60:63], s90 offen offset:0 sc1
  s_waitcnt lgkmcnt(8)
  s_waitcnt vmcnt(14)
  v_mfma_f32_16x16x32_bf16 a[240:243], v[26:29], v[80:83], a[240:243]
  v_mfma_f32_16x16x32_bf16 a[244:247], v[80:83], v[80:83], a[244:247]
  v_mfma_f32_16x16x32_bf16 v[32:35], v[144:147], v[80:83], v[32:35]
  ds_read_b64_tr_b16 v[64:65], v18 offset:24576
  v_mfma_f32_16x16x32_bf16 v[36:39], v[144:147], v[84:87], v[36:39]
  ds_read_b64_tr_b16 v[66:67], v18 offset:25088
  s_add_u32 m0, s92, 57344
  s_mov_b32 s70, 57344
  buffer_load_dwordx4 v30, s[60:63], s70 offen sc1 lds
  v_mfma_f32_16x16x32_bf16 v[40:43], v[144:147], v[88:91], v[40:43]
  ds_read_b64_tr_b16 v[68:69], v19 offset:24576
  v_mfma_f32_16x16x32_bf16 v[44:47], v[144:147], v[92:95], v[44:47]
  ds_read_b64_tr_b16 v[70:71], v19 offset:25088
  s_add_u32 m0, s92, 61440
  s_mov_b32 s70, 61440
  buffer_load_dwordx4 v30, s[60:63], s70 offen sc1 lds
  v_mfma_f32_16x16x32_bf16 v[48:51], v[208:211], v[80:83], v[48:51]
  ds_read_b64_tr_b16 v[72:73], v20 offset:24576
  v_mfma_f32_16x16x32_bf16 v[52:55], v[208:211], v[84:87], v[52:55]
  ds_read_b64_tr_b16 v[74:75], v20 offset:25088
  buffer_load_dwordx4 v[164:167], v16, s[60:63], s90 offen offset:1024 sc1
  v_mfma_f32_16x16x32_bf16 v[56:59], v[208:211], v[88:91], v[56:59]
  ds_read_b64_tr_b16 v[76:77], v21 offset:24576
  v_mfma_f32_16x16x32_bf16 v[60:63], v[208:211], v[92:95], v[60:63]
  ds_read_b64_tr_b16 v[78:79], v21 offset:25088
  buffer_load_dwordx4 v[228:231], v17, s[60:63], s90 offen offset:1024 sc1
  s_waitcnt lgkmcnt(8)
  s_waitcnt vmcnt(14)
  v_mfma_f32_16x16x32_bf16 a[240:243], v[26:29], v[96:99], a[240:243]
  v_mfma_f32_16x16x32_bf16 a[244:247], v[96:99], v[96:99], a[244:247]
  v_mfma_f32_16x16x32_bf16 v[32:35], v[148:151], v[96:99], v[32:35]
  ds_read_b64_tr_b16 v[80:81], v18 offset:28672
  v_mfma_f32_16x16x32_bf16 v[36:39], v[148:151], v[100:103], v[36:39]
  ds_read_b64_tr_b16 v[82:83], v18 offset:29184
  buffer_load_dwordx4 v[168:171], v16, s[60:63], s90 offen offset:2048 sc1
  v_mfma_f32_16x16x32_bf16 v[40:43], v[148:151], v[104:107], v[40:43]
  ds_read_b64_tr_b16 v[84:85], v19 offset:28672
  v_mfma_f32_16x16x32_bf16 v[44:47], v[148:151], v[108:111], v[44:47]
  ds_read_b64_tr_b16 v[86:87], v19 offset:29184
  buffer_load_dwordx4 v[232:235], v17, s[60:63], s90 offen offset:2048 sc1
  v_mfma_f32_16x16x32_bf16 v[48:51], v[212:215], v[96:99], v[48:51]
  ds_read_b64_tr_b16 v[88:89], v20 offset:28672
  v_mfma_f32_16x16x32_bf16 v[52:55], v[212:215], v[100:103], v[52:55]
  ds_read_b64_tr_b16 v[90:91], v20 offset:29184
  buffer_load_dwordx4 v[172:175], v16, s[60:63], s90 offen offset:3072 sc1
  v_mfma_f32_16x16x32_bf16 v[56:59], v[212:215], v[104:107], v[56:59]
  ds_read_b64_tr_b16 v[92:93], v21 offset:28672
  v_mfma_f32_16x16x32_bf16 v[60:63], v[212:215], v[108:111], v[60:63]
  ds_read_b64_tr_b16 v[94:95], v21 offset:29184
  buffer_load_dwordx4 v[236:239], v17, s[60:63], s90 offen offset:3072 sc1
  s_waitcnt vmcnt(16)
  s_barrier
  s_waitcnt lgkmcnt(8)
  s_waitcnt vmcnt(14)
  v_mfma_f32_16x16x32_bf16 a[240:243], v[26:29], v[64:67], a[240:243]
  v_mfma_f32_16x16x32_bf16 a[244:247], v[64:67], v[64:67], a[244:247]
  v_mfma_f32_16x16x32_bf16 v[32:35], v[152:155], v[64:67], v[32:35]
  ds_read_b64_tr_b16 v[96:97], v18 offset:32768
  v_mfma_f32_16x16x32_bf16 v[36:39], v[152:155], v[68:71], v[36:39]
  ds_read_b64_tr_b16 v[98:99], v18 offset:33280
  buffer_load_dwordx4 v[176:179], v16, s[60:63], s91 offen offset:0 sc1
  v_mfma_f32_16x16x32_bf16 v[40:43], v[152:155], v[72:75], v[40:43]
  ds_read_b64_tr_b16 v[100:101], v19 offset:32768
  v_mfma_f32_16x16x32_bf16 v[44:47], v[152:155], v[76:79], v[44:47]
  ds_read_b64_tr_b16 v[102:103], v19 offset:33280
  buffer_load_dwordx4 v[240:243], v17, s[60:63], s91 offen offset:0 sc1
  v_mfma_f32_16x16x32_bf16 v[48:51], v[216:219], v[64:67], v[48:51]
  ds_read_b64_tr_b16 v[104:105], v20 offset:32768
  v_mfma_f32_16x16x32_bf16 v[52:55], v[216:219], v[68:71], v[52:55]
  ds_read_b64_tr_b16 v[106:107], v20 offset:33280
  buffer_load_dwordx4 v[180:183], v16, s[60:63], s91 offen offset:1024 sc1
  v_mfma_f32_16x16x32_bf16 v[56:59], v[216:219], v[72:75], v[56:59]
  ds_read_b64_tr_b16 v[108:109], v21 offset:32768
  v_mfma_f32_16x16x32_bf16 v[60:63], v[216:219], v[76:79], v[60:63]
  ds_read_b64_tr_b16 v[110:111], v21 offset:33280
  buffer_load_dwordx4 v[244:247], v17, s[60:63], s91 offen offset:1024 sc1
  s_waitcnt lgkmcnt(8)
  s_waitcnt vmcnt(16)
  v_mfma_f32_16x16x32_bf16 a[240:243], v[26:29], v[80:83], a[240:243]
  v_mfma_f32_16x16x32_bf16 a[244:247], v[80:83], v[80:83], a[244:247]
  v_mfma_f32_16x16x32_bf16 v[32:35], v[156:159], v[80:83], v[32:35]
  ds_read_b64_tr_b16 v[64:65], v18 offset:36864
  v_mfma_f32_16x16x32_bf16 v[36:39], v[156:159], v[84:87], v[36:39]
  ds_read_b64_tr_b16 v[66:67], v18 offset:37376
  buffer_load_dwordx4 v[184:187], v16, s[60:63], s91 offen offset:2048 sc1
  v_mfma_f32_16x16x32_bf16 v[40:43], v[156:159], v[88:91], v[40:43]
  ds_read_b64_tr_b16 v[68:69], v19 offset:36864
  v_mfma_f32_16x16x32_bf16 v[44:47], v[156:159], v[92:95], v[44:47]
  ds_read_b64_tr_b16 v[70:71], v19 offset:37376
  buffer_load_dwordx4 v[248:251], v17, s[60:63], s91 offen offset:2048 sc1
  v_mfma_f32_16x16x32_bf16 v[48:51], v[220:223], v[80:83], v[48:51]
  ds_read_b64_tr_b16 v[72:73], v20 offset:36864
  v_mfma_f32_16x16x32_bf16 v[52:55], v[220:223], v[84:87], v[52:55]
  ds_read_b64_tr_b16 v[74:75], v20 offset:37376
  buffer_load_dwordx4 v[188:191], v16, s[60:63], s91 offen offset:3072 sc1
  v_mfma_f32_16x16x32_bf16 v[56:59], v[220:223], v[88:91], v[56:59]
  ds_read_b64_tr_b16 v[76:77], v21 offset:36864
  v_mfma_f32_16x16x32_bf16 v[60:63], v[220:223], v[92:95], v[60:63]
  ds_read_b64_tr_b16 v[78:79], v21 offset:37376
  buffer_load_dwordx4 v[252:255], v17, s[60:63], s91 offen offset:3072 sc1
  s_waitcnt lgkmcnt(8)
  s_waitcnt vmcnt(16)
  v_mfma_f32_16x16x32_bf16 a[240:243], v[26:29], v[96:99], a[240:243]
  v_mfma_f32_16x16x32_bf16 a[244:247], v[96:99], v[96:99], a[244:247]
  v_mfma_f32_16x16x32_bf16 v[32:35], v[160:163], v[96:99], v[32:35]
  ds_read_b64_tr_b16 v[80:81], v18 offset:40960
  v_mfma_f32_16x16x32_bf16 v[36:39], v[160:163], v[100:103], v[36:39]
  ds_read_b64_tr_b16 v[82:83], v18 offset:41472
  s_mov_b32 s70, 7168
  buffer_load_dword v112, v31, s[60:63], s70 offen sc1
  v_mfma_f32_16x16x32_bf16 v[40:43], v[160:163], v[104:107], v[40:43]
  ds_read_b64_tr_b16 v[84:85], v19 offset:40960
  v_mfma_f32_16x16x32_bf16 v[44:47], v[160:163], v[108:111], v[44:47]
  ds_read_b64_tr_b16 v[86:87], v19 offset:41472
  s_mov_b32 s70, 21504
  buffer_load_dword v113, v31, s[60:63], s70 offen sc1
  v_mfma_f32_16x16x32_bf16 v[48:51], v[224:227], v[96:99], v[48:51]
  ds_read_b64_tr_b16 v[88:89], v20 offset:40960
  v_mfma_f32_16x16x32_bf16 v[52:55], v[224:227], v[100:103], v[52:55]
  ds_read_b64_tr_b16 v[90:91], v20 offset:41472
  s_mov_b32 s70, 35840
  buffer_load_dword v114, v31, s[60:63], s70 offen sc1
  v_mfma_f32_16x16x32_bf16 v[56:59], v[224:227], v[104:107], v[56:59]
  ds_read_b64_tr_b16 v[92:93], v21 offset:40960
  v_mfma_f32_16x16x32_bf16 v[60:63], v[224:227], v[108:111], v[60:63]
  ds_read_b64_tr_b16 v[94:95], v21 offset:41472
  s_mov_b32 s70, 50176
  buffer_load_dword v115, v31, s[60:63], s70 offen sc1
  s_waitcnt lgkmcnt(8)
  s_waitcnt vmcnt(16)
  v_mfma_f32_16x16x32_bf16 a[240:243], v[26:29], v[64:67], a[240:243]
  v_mfma_f32_16x16x32_bf16 a[244:247], v[64:67], v[64:67], a[244:247]
  v_mfma_f32_16x16x32_bf16 v[32:35], v[164:167], v[64:67], v[32:35]
  ds_read_b64_tr_b16 v[96:97], v18 offset:45056
  v_mfma_f32_16x16x32_bf16 v[36:39], v[164:167], v[68:71], v[36:39]
  ds_read_b64_tr_b16 v[98:99], v18 offset:45568
  s_mov_b32 s70, 64512
  buffer_load_dword v116, v31, s[60:63], s70 offen sc1
  v_mfma_f32_16x16x32_bf16 v[40:43], v[164:167], v[72:75], v[40:43]
  ds_read_b64_tr_b16 v[100:101], v19 offset:45056
  v_mfma_f32_16x16x32_bf16 v[44:47], v[164:167], v[76:79], v[44:47]
  ds_read_b64_tr_b16 v[102:103], v19 offset:45568
  s_mov_b32 s70, 78848
  buffer_load_dword v117, v31, s[60:63], s70 offen sc1
  v_mfma_f32_16x16x32_bf16 v[48:51], v[228:231], v[64:67], v[48:51]
  ds_read_b64_tr_b16 v[104:105], v20 offset:45056
  v_mfma_f32_16x16x32_bf16 v[52:55], v[228:231], v[68:71], v[52:55]
  ds_read_b64_tr_b16 v[106:107], v20 offset:45568
  s_mov_b32 s70, 93184
  buffer_load_dword v118, v31, s[60:63], s70 offen sc1
  v_mfma_f32_16x16x32_bf16 v[56:59], v[228:231], v[72:75], v[56:59]
  ds_read_b64_tr_b16 v[108:109], v21 offset:45056
  v_mfma_f32_16x16x32_bf16 v[60:63], v[228:231], v[76:79], v[60:63]
  ds_read_b64_tr_b16 v[110:111], v21 offset:45568
  s_mov_b32 s70, 107520
  buffer_load_dword v119, v31, s[60:63], s70 offen sc1
  s_barrier
  s_waitcnt lgkmcnt(8)
  s_waitcnt vmcnt(18)
  v_mfma_f32_16x16x32_bf16 a[240:243], v[26:29], v[80:83], a[240:243]
  v_mfma_f32_16x16x32_bf16 a[244:247], v[80:83], v[80:83], a[244:247]
  v_mfma_f32_16x16x32_bf16 v[32:35], v[168:171], v[80:83], v[32:35]
  ds_read_b64_tr_b16 v[64:65], v18 offset:49152
  v_mfma_f32_16x16x32_bf16 v[36:39], v[168:171], v[84:87], v[36:39]
  ds_read_b64_tr_b16 v[66:67], v18 offset:49664
  s_mov_b32 s70, 0
  buffer_load_dword v120, v31, s[60:63], s70 offen sc1
  v_mfma_f32_16x16x32_bf16 v[40:43], v[168:171], v[88:91], v[40:43]
  ds_read_b64_tr_b16 v[68:69], v19 offset:49152
  v_mfma_f32_16x16x32_bf16 v[44:47], v[168:171], v[92:95], v[44:47]
  ds_read_b64_tr_b16 v[70:71], v19 offset:49664
  s_mov_b32 s70, 14336
  buffer_load_dword v121, v31, s[60:63], s70 offen sc1
  v_mfma_f32_16x16x32_bf16 v[48:51], v[232:235], v[80:83], v[48:51]
  ds_read_b64_tr_b16 v[72:73], v20 offset:49152
  v_mfma_f32_16x16x32_bf16 v[52:55], v[232:235], v[84:87], v[52:55]
  ds_read_b64_tr_b16 v[74:75], v20 offset:49664
  s_mov_b32 s70, 28672
  buffer_load_dword v122, v31, s[60:63], s70 offen sc1
  v_mfma_f32_16x16x32_bf16 v[56:59], v[232:235], v[88:91], v[56:59]
  ds_read_b64_tr_b16 v[76:77], v21 offset:49152
  v_mfma_f32_16x16x32_bf16 v[60:63], v[232:235], v[92:95], v[60:63]
  ds_read_b64_tr_b16 v[78:79], v21 offset:49664
  s_mov_b32 s70, 43008
  buffer_load_dword v123, v31, s[60:63], s70 offen sc1
  s_waitcnt lgkmcnt(8)
  s_waitcnt vmcnt(20)
  v_mfma_f32_16x16x32_bf16 a[240:243], v[26:29], v[96:99], a[240:243]
  v_mfma_f32_16x16x32_bf16 a[244:247], v[96:99], v[96:99], a[244:247]
  v_mfma_f32_16x16x32_bf16 v[32:35], v[172:175], v[96:99], v[32:35]
  ds_read_b64_tr_b16 v[80:81], v18 offset:53248
  v_mfma_f32_16x16x32_bf16 v[36:39], v[172:175], v[100:103], v[36:39]
  ds_read_b64_tr_b16 v[82:83], v18 offset:53760
  s_mov_b32 s70, 57344
  buffer_load_dword v124, v31, s[60:63], s70 offen sc1
  v_mfma_f32_16x16x32_bf16 v[40:43], v[172:175], v[104:107], v[40:43]
  ds_read_b64_tr_b16 v[84:85], v19 offset:53248
  v_mfma_f32_16x16x32_bf16 v[44:47], v[172:175], v[108:111], v[44:47]
  ds_read_b64_tr_b16 v[86:87], v19 offset:53760
  s_mov_b32 s70, 71680
  buffer_load_dword v125, v31, s[60:63], s70 offen sc1
  v_mfma_f32_16x16x32_bf16 v[48:51], v[236:239], v[96:99], v[48:51]
  ds_read_b64_tr_b16 v[88:89], v20 offset:53248
  v_mfma_f32_16x16x32_bf16 v[52:55], v[236:239], v[100:103], v[52:55]
  ds_read_b64_tr_b16 v[90:91], v20 offset:53760
  s_mov_b32 s70, 86016
  buffer_load_dword v126, v31, s[60:63], s70 offen sc1
  v_mfma_f32_16x16x32_bf16 v[56:59], v[236:239], v[104:107], v[56:59]
  ds_read_b64_tr_b16 v[92:93], v21 offset:53248
  v_mfma_f32_16x16x32_bf16 v[60:63], v[236:239], v[108:111], v[60:63]
  ds_read_b64_tr_b16 v[94:95], v21 offset:53760
  s_mov_b32 s70, 100352
  buffer_load_dword v127, v31, s[60:63], s70 offen sc1
  s_waitcnt lgkmcnt(8)
  s_waitcnt vmcnt(22)
  v_mfma_f32_16x16x32_bf16 a[240:243], v[26:29], v[64:67], a[240:243]
  v_mfma_f32_16x16x32_bf16 a[244:247], v[64:67], v[64:67], a[244:247]
  v_mfma_f32_16x16x32_bf16 v[32:35], v[176:179], v[64:67], v[32:35]
  ds_read_b64_tr_b16 v[96:97], v18 offset:57344
  v_mfma_f32_16x16x32_bf16 v[36:39], v[176:179], v[68:71], v[36:39]
  ds_read_b64_tr_b16 v[98:99], v18 offset:57856
  v_subrev_u32 v16, 917504, v16
  v_subrev_u32 v17, 917504, v17
  buffer_load_dwordx4 v[128:131], v16, s[60:63], 0 offen offset:0 sc1
  v_mfma_f32_16x16x32_bf16 v[40:43], v[176:179], v[72:75], v[40:43]
  ds_read_b64_tr_b16 v[100:101], v19 offset:57344
  v_mfma_f32_16x16x32_bf16 v[44:47], v[176:179], v[76:79], v[44:47]
  ds_read_b64_tr_b16 v[102:103], v19 offset:57856
  buffer_load_dwordx4 v[192:195], v17, s[60:63], 0 offen offset:0 sc1
  v_mfma_f32_16x16x32_bf16 v[48:51], v[240:243], v[64:67], v[48:51]
  ds_read_b64_tr_b16 v[104:105], v20 offset:57344
  v_mfma_f32_16x16x32_bf16 v[52:55], v[240:243], v[68:71], v[52:55]
  ds_read_b64_tr_b16 v[106:107], v20 offset:57856
  buffer_load_dwordx4 v[132:135], v16, s[60:63], 0 offen offset:1024 sc1
  v_mfma_f32_16x16x32_bf16 v[56:59], v[240:243], v[72:75], v[56:59]
  ds_read_b64_tr_b16 v[108:109], v21 offset:57344
  v_mfma_f32_16x16x32_bf16 v[60:63], v[240:243], v[76:79], v[60:63]
  ds_read_b64_tr_b16 v[110:111], v21 offset:57856
  buffer_load_dwordx4 v[196:199], v17, s[60:63], 0 offen offset:1024 sc1
  s_waitcnt lgkmcnt(8)
  s_waitcnt vmcnt(24)
  v_mfma_f32_16x16x32_bf16 a[240:243], v[26:29], v[80:83], a[240:243]
  v_mfma_f32_16x16x32_bf16 a[244:247], v[80:83], v[80:83], a[244:247]
  v_mfma_f32_16x16x32_bf16 v[32:35], v[180:183], v[80:83], v[32:35]
  ds_read_b64_tr_b16 v[64:65], v18 offset:61440
  v_mfma_f32_16x16x32_bf16 v[36:39], v[180:183], v[84:87], v[36:39]
  ds_read_b64_tr_b16 v[66:67], v18 offset:61952
  buffer_load_dwordx4 v[136:139], v16, s[60:63], 0 offen offset:2048 sc1
  v_mfma_f32_16x16x32_bf16 v[40:43], v[180:183], v[88:91], v[40:43]
  ds_read_b64_tr_b16 v[68:69], v19 offset:61440
  v_mfma_f32_16x16x32_bf16 v[44:47], v[180:183], v[92:95], v[44:47]
  ds_read_b64_tr_b16 v[70:71], v19 offset:61952
  buffer_load_dwordx4 v[200:203], v17, s[60:63], 0 offen offset:2048 sc1
  v_mfma_f32_16x16x32_bf16 v[48:51], v[244:247], v[80:83], v[48:51]
  ds_read_b64_tr_b16 v[72:73], v20 offset:61440
  v_mfma_f32_16x16x32_bf16 v[52:55], v[244:247], v[84:87], v[52:55]
  ds_read_b64_tr_b16 v[74:75], v20 offset:61952
  buffer_load_dwordx4 v[140:143], v16, s[60:63], 0 offen offset:3072 sc1
  v_mfma_f32_16x16x32_bf16 v[56:59], v[244:247], v[88:91], v[56:59]
  ds_read_b64_tr_b16 v[76:77], v21 offset:61440
  v_mfma_f32_16x16x32_bf16 v[60:63], v[244:247], v[92:95], v[60:63]
  ds_read_b64_tr_b16 v[78:79], v21 offset:61952
  buffer_load_dwordx4 v[204:207], v17, s[60:63], 0 offen offset:3072 sc1
  s_waitcnt lgkmcnt(8)
  s_waitcnt vmcnt(26)
  v_mfma_f32_16x16x32_bf16 a[240:243], v[26:29], v[96:99], a[240:243]
  v_mfma_f32_16x16x32_bf16 a[244:247], v[96:99], v[96:99], a[244:247]
  v_mfma_f32_16x16x32_bf16 v[32:35], v[184:187], v[96:99], v[32:35]
  v_mfma_f32_16x16x32_bf16 v[36:39], v[184:187], v[100:103], v[36:39]
  buffer_load_dwordx4 v[144:147], v16, s[60:63], s89 offen offset:0 sc1
  v_mfma_f32_16x16x32_bf16 v[40:43], v[184:187], v[104:107], v[40:43]
  v_mfma_f32_16x16x32_bf16 v[44:47], v[184:187], v[108:111], v[44:47]
  buffer_load_dwordx4 v[208:211], v17, s[60:63], s89 offen offset:0 sc1
  v_mfma_f32_16x16x32_bf16 v[48:51], v[248:251], v[96:99], v[48:51]
  v_mfma_f32_16x16x32_bf16 v[52:55], v[248:251], v[100:103], v[52:55]
  buffer_load_dwordx4 v[148:151], v16, s[60:63], s89 offen offset:1024 sc1
  v_mfma_f32_16x16x32_bf16 v[56:59], v[248:251], v[104:107], v[56:59]
  v_mfma_f32_16x16x32_bf16 v[60:63], v[248:251], v[108:111], v[60:63]
  buffer_load_dwordx4 v[212:215], v17, s[60:63], s89 offen offset:1024 sc1
  s_waitcnt lgkmcnt(0)
  s_waitcnt vmcnt(28)
  v_mfma_f32_16x16x32_bf16 a[240:243], v[26:29], v[64:67], a[240:243]
  v_mfma_f32_16x16x32_bf16 a[244:247], v[64:67], v[64:67], a[244:247]
  v_mfma_f32_16x16x32_bf16 v[32:35], v[188:191], v[64:67], v[32:35]
  v_mfma_f32_16x16x32_bf16 v[36:39], v[188:191], v[68:71], v[36:39]
  buffer_load_dwordx4 v[152:155], v16, s[60:63], s89 offen offset:2048 sc1
  v_mfma_f32_16x16x32_bf16 v[40:43], v[188:191], v[72:75], v[40:43]
  v_mfma_f32_16x16x32_bf16 v[44:47], v[188:191], v[76:79], v[44:47]
  buffer_load_dwordx4 v[216:219], v17, s[60:63], s89 offen offset:2048 sc1
  v_mfma_f32_16x16x32_bf16 v[48:51], v[252:255], v[64:67], v[48:51]
  v_mfma_f32_16x16x32_bf16 v[52:55], v[252:255], v[68:71], v[52:55]
  buffer_load_dwordx4 v[156:159], v16, s[60:63], s89 offen offset:3072 sc1
  v_mfma_f32_16x16x32_bf16 v[56:59], v[252:255], v[72:75], v[56:59]
  v_mfma_f32_16x16x32_bf16 v[60:63], v[252:255], v[76:79], v[60:63]
  buffer_load_dwordx4 v[220:223], v17, s[60:63], s89 offen offset:3072 sc1
  v_accvgpr_read_b32 v64, a240
  v_accvgpr_read_b32 v66, a244
  v_accvgpr_read_b32 v67, a245
  v_accvgpr_read_b32 v68, a246
  v_accvgpr_read_b32 v69, a247
  v_and_b32 v70, 1, v2
  v_cmp_eq_u32 vcc, 1, v70
  s_nop 1
  v_cndmask_b32 v66, v66, v67, vcc
  v_cndmask_b32 v68, v68, v69, vcc
  v_and_b32 v70, 2, v2
  v_cmp_eq_u32 vcc, 2, v70
  v_mul_f32 v64, 0xbb000000, v64
  s_nop 0
  v_cndmask_b32 v65, v66, v68, vcc
  v_mul_f32 v66, v64, v64
  v_mov_b32 v67, 0x3b000000
  v_fma_f32 v65, v65, v67, -v66
  v_max_f32 v65, 0, v65
  v_add_f32 v65, 0x3727c5ac, v65
  v_rsq_f32 v65, v65
  s_mov_b32 exec_lo, 0x00f0000f
  s_mov_b32 exec_hi, 0xf0000f00
  ds_write_b64 v22, v[64:65]
  s_mov_b64 exec, -1
  s_waitcnt vmcnt(16)
  v_add_f32 v112, v112, v116
  v_add_f32 v120, v120, v124
  v_add_f32 v113, v113, v117
  v_add_f32 v121, v121, v125
  v_add_f32 v114, v114, v118
  v_add_f32 v122, v122, v126
  v_add_f32 v115, v115, v119
  v_add_f32 v123, v123, v127
  v_add_f32 v112, v112, v114
  v_add_f32 v120, v120, v122
  v_add_f32 v113, v113, v115
  v_add_f32 v121, v121, v123
  v_add_f32 v112, v112, v113
  v_add_f32 v120, v120, v121
  s_lshl_b32 s70, s66, 9
  s_add_u32 s70, s70, 156672
  v_lshl_add_u32 v70, v1, 2, s70
  v_lshl_add_u32 v31, v3, 4, s70
  ds_write_b32 v70, v112
  ds_write_b32 v70, v120 offset:256
  s_lshl_b32 s70, s66, 11
  s_sub_u32 s70, s70, 8192
  v_lshl_add_u32 v88, v3, 9, s70
  v_add_u32 v89, v88, v22
  v_add_u32 v90, v88, v23
  v_add_u32 v91, v88, v24
  v_add_u32 v92, v88, v25
  v_lshrrev_b32 v5, 2, v0
  v_lshlrev_b32 v5, 3, v5
  v_and_b32 v88, 3, v0
  v_lshl_add_u32 v88, v88, 11, v5
  v_add_u32 v88, 147456, v88
  s_lshl_b32 s70, s67, 3
  s_add_u32 s70, s70, s68
  s_lshl_b32 s70, s70, 9
  s_add_u32 s70, s70, 65536
  v_add_u32 v93, s70, v5
  s_waitcnt lgkmcnt(0)
  s_barrier
  ds_read_b128 v[96:99], v31 offset:0
  ds_read_b128 v[100:103], v31 offset:128
  ds_read_b128 v[104:107], v31 offset:64
  ds_read_b128 v[108:111], v31 offset:192
  ds_read_b64 v[64:65], v22
  ds_read_b64 v[66:67], v23
  ds_read_b64 v[68:69], v24
  ds_read_b64 v[70:71], v25
  s_waitcnt lgkmcnt(0)
  v_pk_fma_f32 v[32:33], v[64:65], v[96:97], v[32:33] op_sel_hi:[0,1,1]
  v_pk_fma_f32 v[34:35], v[64:65], v[98:99], v[34:35] op_sel_hi:[0,1,1]
  v_pk_fma_f32 v[32:33], v[32:33], v[64:65], v[104:105] op_sel:[0,1,0] op_sel_hi:[1,1,1]
  v_pk_fma_f32 v[34:35], v[34:35], v[64:65], v[106:107] op_sel:[0,1,0] op_sel_hi:[1,1,1]
  v_pk_fma_f32 v[36:37], v[66:67], v[96:97], v[36:37] op_sel_hi:[0,1,1]
  v_pk_fma_f32 v[38:39], v[66:67], v[98:99], v[38:39] op_sel_hi:[0,1,1]
  v_pk_fma_f32 v[36:37], v[36:37], v[66:67], v[104:105] op_sel:[0,1,0] op_sel_hi:[1,1,1]
  v_pk_fma_f32 v[38:39], v[38:39], v[66:67], v[106:107] op_sel:[0,1,0] op_sel_hi:[1,1,1]
  v_pk_fma_f32 v[40:41], v[68:69], v[96:97], v[40:41] op_sel_hi:[0,1,1]
  s_add_u32 m0, s84, 0
  s_add_u32 s74, s85, 896
  s_and_b32 s74, s74, 0x3ff
  v_add_u32 v12, s74, v8
  buffer_load_dwordx4 v12, s[32:35], s80 offen lds
  s_add_u32 m0, m0, 1024
  v_pk_fma_f32 v[42:43], v[68:69], v[98:99], v[42:43] op_sel_hi:[0,1,1]
  v_pk_fma_f32 v[40:41], v[40:41], v[68:69], v[104:105] op_sel:[0,1,0] op_sel_hi:[1,1,1]
  v_pk_fma_f32 v[42:43], v[42:43], v[68:69], v[106:107] op_sel:[0,1,0] op_sel_hi:[1,1,1]
  v_pk_fma_f32 v[44:45], v[70:71], v[96:97], v[44:45] op_sel_hi:[0,1,1]
  v_pk_fma_f32 v[46:47], v[70:71], v[98:99], v[46:47] op_sel_hi:[0,1,1]
  v_pk_fma_f32 v[44:45], v[44:45], v[70:71], v[104:105] op_sel:[0,1,0] op_sel_hi:[1,1,1]
  v_pk_fma_f32 v[46:47], v[46:47], v[70:71], v[106:107] op_sel:[0,1,0] op_sel_hi:[1,1,1]
  v_pk_mul_f32 v[72:73], v[32:33], v[32:33]
  v_pk_mul_f32 v[74:75], v[34:35], v[34:35]
  buffer_load_dwordx4 v12, s[32:35], s4 offen lds
  s_add_u32 m0, m0, 1024
  v_pk_mul_f32 v[76:77], v[36:37], v[36:37]
  v_pk_mul_f32 v[78:79], v[38:39], v[38:39]
  v_pk_fma_f32 v[72:73], v[72:73], v[14:15], v[14:15] op_sel:[0,1,0] op_sel_hi:[1,1,0]
  v_pk_fma_f32 v[74:75], v[74:75], v[14:15], v[14:15] op_sel:[0,1,0] op_sel_hi:[1,1,0]
  v_pk_fma_f32 v[76:77], v[76:77], v[14:15], v[14:15] op_sel:[0,1,0] op_sel_hi:[1,1,0]
  v_pk_fma_f32 v[78:79], v[78:79], v[14:15], v[14:15] op_sel:[0,1,0] op_sel_hi:[1,1,0]
  v_pk_mul_f32 v[72:73], v[72:73], v[32:33]
  v_pk_mul_f32 v[74:75], v[74:75], v[34:35]
  v_pk_mul_f32 v[76:77], v[76:77], v[36:37]
  buffer_load_dwordx4 v12, s[32:35], s81 offen lds
  s_add_u32 m0, m0, 1024
  v_pk_mul_f32 v[78:79], v[78:79], v[38:39]
  v_exp_f32 v72, v72
  v_exp_f32 v73, v73
  v_exp_f32 v74, v74
  v_exp_f32 v75, v75
  v_exp_f32 v76, v76
  v_exp_f32 v77, v77
  v_exp_f32 v78, v78
  v_exp_f32 v79, v79
  buffer_load_dwordx4 v12, s[32:35], s5 offen lds
  s_add_u32 m0, m0, 1024
  v_pk_add_f32 v[72:73], v[72:73], 1.0 op_sel_hi:[1,0]
  v_pk_add_f32 v[74:75], v[74:75], 1.0 op_sel_hi:[1,0]
  v_pk_add_f32 v[76:77], v[76:77], 1.0 op_sel_hi:[1,0]
  v_pk_add_f32 v[78:79], v[78:79], 1.0 op_sel_hi:[1,0]
  v_rcp_f32 v72, v72
  v_rcp_f32 v73, v73
  v_rcp_f32 v74, v74
  v_rcp_f32 v75, v75
  v_rcp_f32 v76, v76
  buffer_load_dwordx4 v12, s[32:35], s82 offen lds
  s_add_u32 m0, m0, 1024
  v_rcp_f32 v77, v77
  v_rcp_f32 v78, v78
  v_rcp_f32 v79, v79
  v_pk_mul_f32 v[72:73], v[72:73], v[32:33]
  v_pk_mul_f32 v[74:75], v[74:75], v[34:35]
  v_pk_mul_f32 v[76:77], v[76:77], v[36:37]
  v_pk_mul_f32 v[78:79], v[78:79], v[38:39]
  v_cvt_pk_bf16_f32 v112, v72, v73
  v_cvt_pk_bf16_f32 v113, v74, v75
  buffer_load_dwordx4 v12, s[32:35], s6 offen lds
  s_add_u32 m0, m0, 1024
  v_cvt_pk_bf16_f32 v114, v76, v77
  v_cvt_pk_bf16_f32 v115, v78, v79
  v_pk_mul_f32 v[72:73], v[40:41], v[40:41]
  v_pk_mul_f32 v[74:75], v[42:43], v[42:43]
  v_pk_mul_f32 v[76:77], v[44:45], v[44:45]
  v_pk_mul_f32 v[78:79], v[46:47], v[46:47]
  v_pk_fma_f32 v[72:73], v[72:73], v[14:15], v[14:15] op_sel:[0,1,0] op_sel_hi:[1,1,0]
  v_pk_fma_f32 v[74:75], v[74:75], v[14:15], v[14:15] op_sel:[0,1,0] op_sel_hi:[1,1,0]
  v_pk_fma_f32 v[76:77], v[76:77], v[14:15], v[14:15] op_sel:[0,1,0] op_sel_hi:[1,1,0]
  buffer_load_dwordx4 v12, s[32:35], s83 offen lds
  s_add_u32 m0, m0, 1024
  v_pk_fma_f32 v[78:79], v[78:79], v[14:15], v[14:15] op_sel:[0,1,0] op_sel_hi:[1,1,0]
  v_pk_mul_f32 v[72:73], v[72:73], v[40:41]
  v_pk_mul_f32 v[74:75], v[74:75], v[42:43]
  v_pk_mul_f32 v[76:77], v[76:77], v[44:45]
  v_pk_mul_f32 v[78:79], v[78:79], v[46:47]
  v_exp_f32 v72, v72
  v_exp_f32 v73, v73
  v_exp_f32 v74, v74
  v_exp_f32 v75, v75
  buffer_load_dwordx4 v12, s[32:35], s7 offen lds
  v_exp_f32 v76, v76
  v_exp_f32 v77, v77
  v_exp_f32 v78, v78
  v_exp_f32 v79, v79
  v_pk_add_f32 v[72:73], v[72:73], 1.0 op_sel_hi:[1,0]
  v_pk_add_f32 v[74:75], v[74:75], 1.0 op_sel_hi:[1,0]
  v_pk_add_f32 v[76:77], v[76:77], 1.0 op_sel_hi:[1,0]
  v_pk_add_f32 v[78:79], v[78:79], 1.0 op_sel_hi:[1,0]
  v_rcp_f32 v72, v72
  buffer_load_dwordx4 v[160:163], v16, s[60:63], s90 offen offset:0 sc1
  v_rcp_f32 v73, v73
  v_rcp_f32 v74, v74
  v_rcp_f32 v75, v75
  v_rcp_f32 v76, v76
  v_rcp_f32 v77, v77
  v_rcp_f32 v78, v78
  v_rcp_f32 v79, v79
  v_pk_mul_f32 v[72:73], v[72:73], v[40:41]
  v_pk_mul_f32 v[74:75], v[74:75], v[42:43]
  buffer_load_dwordx4 v[224:227], v17, s[60:63], s90 offen offset:0 sc1
  v_pk_mul_f32 v[76:77], v[76:77], v[44:45]
  v_pk_mul_f32 v[78:79], v[78:79], v[46:47]
  v_cvt_pk_bf16_f32 v116, v72, v73
  v_cvt_pk_bf16_f32 v117, v74, v75
  v_cvt_pk_bf16_f32 v118, v76, v77
  v_cvt_pk_bf16_f32 v119, v78, v79
  v_dot2_f32_bf16 v80, v112, v26, 0
  v_dot2_f32_bf16 v81, v112, v112, 0
  v_dot2_f32_bf16 v80, v113, v26, v80
  buffer_load_dwordx4 v[164:167], v16, s[60:63], s90 offen offset:1024 sc1
  v_dot2_f32_bf16 v81, v113, v113, v81
  v_dot2_f32_bf16 v82, v114, v26, 0
  v_dot2_f32_bf16 v83, v114, v114, 0
  v_dot2_f32_bf16 v82, v115, v26, v82
  v_dot2_f32_bf16 v83, v115, v115, v83
  v_dot2_f32_bf16 v84, v116, v26, 0
  v_dot2_f32_bf16 v85, v116, v116, 0
  v_dot2_f32_bf16 v84, v117, v26, v84
  v_dot2_f32_bf16 v85, v117, v117, v85
  buffer_load_dwordx4 v[228:231], v17, s[60:63], s90 offen offset:1024 sc1
  v_dot2_f32_bf16 v86, v118, v26, 0
  v_dot2_f32_bf16 v87, v118, v118, 0
  v_dot2_f32_bf16 v86, v119, v26, v86
  v_dot2_f32_bf16 v87, v119, v119, v87
  s_cmp_eq_u32 s66, 3
  s_cbranch_scc1 L_g1skip
  v_pk_fma_f32 v[48:49], v[64:65], v[100:101], v[48:49] op_sel_hi:[0,1,1]
  v_pk_fma_f32 v[50:51], v[64:65], v[102:103], v[50:51] op_sel_hi:[0,1,1]
  v_pk_fma_f32 v[48:49], v[48:49], v[64:65], v[108:109] op_sel:[0,1,0] op_sel_hi:[1,1,1]
  v_pk_fma_f32 v[50:51], v[50:51], v[64:65], v[110:111] op_sel:[0,1,0] op_sel_hi:[1,1,1]
  v_pk_fma_f32 v[52:53], v[66:67], v[100:101], v[52:53] op_sel_hi:[0,1,1]
  v_pk_fma_f32 v[54:55], v[66:67], v[102:103], v[54:55] op_sel_hi:[0,1,1]
  v_pk_fma_f32 v[52:53], v[52:53], v[66:67], v[108:109] op_sel:[0,1,0] op_sel_hi:[1,1,1]
  buffer_load_dwordx4 v[168:171], v16, s[60:63], s90 offen offset:2048 sc1
  v_pk_fma_f32 v[54:55], v[54:55], v[66:67], v[110:111] op_sel:[0,1,0] op_sel_hi:[1,1,1]
  v_pk_fma_f32 v[56:57], v[68:69], v[100:101], v[56:57] op_sel_hi:[0,1,1]
  v_pk_fma_f32 v[58:59], v[68:69], v[102:103], v[58:59] op_sel_hi:[0,1,1]
  v_pk_fma_f32 v[56:57], v[56:57], v[68:69], v[108:109] op_sel:[0,1,0] op_sel_hi:[1,1,1]
  v_pk_fma_f32 v[58:59], v[58:59], v[68:69], v[110:111] op_sel:[0,1,0] op_sel_hi:[1,1,1]
  v_pk_fma_f32 v[60:61], v[70:71], v[100:101], v[60:61] op_sel_hi:[0,1,1]
  v_pk_fma_f32 v[62:63], v[70:71], v[102:103], v[62:63] op_sel_hi:[0,1,1]
  buffer_load_dwordx4 v[232:235], v17, s[60:63], s90 offen offset:2048 sc1
  v_pk_fma_f32 v[60:61], v[60:61], v[70:71], v[108:109] op_sel:[0,1,0] op_sel_hi:[1,1,1]
  v_pk_fma_f32 v[62:63], v[62:63], v[70:71], v[110:111] op_sel:[0,1,0] op_sel_hi:[1,1,1]
  v_pk_mul_f32 v[72:73], v[48:49], v[48:49]
  v_pk_mul_f32 v[74:75], v[50:51], v[50:51]
  v_pk_mul_f32 v[76:77], v[52:53], v[52:53]
  v_pk_mul_f32 v[78:79], v[54:55], v[54:55]
  v_pk_fma_f32 v[72:73], v[72:73], v[14:15], v[14:15] op_sel:[0,1,0] op_sel_hi:[1,1,0]
  buffer_load_dwordx4 v[172:175], v16, s[60:63], s90 offen offset:3072 sc1
  v_pk_fma_f32 v[74:75], v[74:75], v[14:15], v[14:15] op_sel:[0,1,0] op_sel_hi:[1,1,0]
  v_pk_fma_f32 v[76:77], v[76:77], v[14:15], v[14:15] op_sel:[0,1,0] op_sel_hi:[1,1,0]
  v_pk_fma_f32 v[78:79], v[78:79], v[14:15], v[14:15] op_sel:[0,1,0] op_sel_hi:[1,1,0]
  v_pk_mul_f32 v[72:73], v[72:73], v[48:49]
  v_pk_mul_f32 v[74:75], v[74:75], v[50:51]
  v_pk_mul_f32 v[76:77], v[76:77], v[52:53]
  v_pk_mul_f32 v[78:79], v[78:79], v[54:55]
  buffer_load_dwordx4 v[236:239], v17, s[60:63], s90 offen offset:3072 sc1
  v_exp_f32 v72, v72
  v_exp_f32 v73, v73
  v_exp_f32 v74, v74
  v_exp_f32 v75, v75
  v_exp_f32 v76, v76
  v_exp_f32 v77, v77
  v_exp_f32 v78, v78
  buffer_load_dwordx4 v[176:179], v16, s[60:63], s91 offen offset:0 sc1
  v_exp_f32 v79, v79
  v_pk_add_f32 v[72:73], v[72:73], 1.0 op_sel_hi:[1,0]
  v_pk_add_f32 v[74:75], v[74:75], 1.0 op_sel_hi:[1,0]
  v_pk_add_f32 v[76:77], v[76:77], 1.0 op_sel_hi:[1,0]
  v_pk_add_f32 v[78:79], v[78:79], 1.0 op_sel_hi:[1,0]
  v_rcp_f32 v72, v72
  v_rcp_f32 v73, v73
  buffer_load_dwordx4 v[240:243], v17, s[60:63], s91 offen offset:0 sc1
  v_rcp_f32 v74, v74
  v_rcp_f32 v75, v75
  v_rcp_f32 v76, v76
  v_rcp_f32 v77, v77
  v_rcp_f32 v78, v78
  v_rcp_f32 v79, v79
  v_pk_mul_f32 v[72:73], v[72:73], v[48:49]
  buffer_load_dwordx4 v[180:183], v16, s[60:63], s91 offen offset:1024 sc1
  v_pk_mul_f32 v[74:75], v[74:75], v[50:51]
  v_pk_mul_f32 v[76:77], v[76:77], v[52:53]
  v_pk_mul_f32 v[78:79], v[78:79], v[54:55]
  v_cvt_pk_bf16_f32 v120, v72, v73
  v_cvt_pk_bf16_f32 v121, v74, v75
  v_cvt_pk_bf16_f32 v122, v76, v77
  v_cvt_pk_bf16_f32 v123, v78, v79
  buffer_load_dwordx4 v[244:247], v17, s[60:63], s91 offen offset:1024 sc1
  v_pk_mul_f32 v[72:73], v[56:57], v[56:57]
  v_pk_mul_f32 v[74:75], v[58:59], v[58:59]
  v_pk_mul_f32 v[76:77], v[60:61], v[60:61]
  v_pk_mul_f32 v[78:79], v[62:63], v[62:63]
  v_pk_fma_f32 v[72:73], v[72:73], v[14:15], v[14:15] op_sel:[0,1,0] op_sel_hi:[1,1,0]
  v_pk_fma_f32 v[74:75], v[74:75], v[14:15], v[14:15] op_sel:[0,1,0] op_sel_hi:[1,1,0]
  v_pk_fma_f32 v[76:77], v[76:77], v[14:15], v[14:15] op_sel:[0,1,0] op_sel_hi:[1,1,0]
  buffer_load_dwordx4 v[184:187], v16, s[60:63], s91 offen offset:2048 sc1
  v_pk_fma_f32 v[78:79], v[78:79], v[14:15], v[14:15] op_sel:[0,1,0] op_sel_hi:[1,1,0]
  v_pk_mul_f32 v[72:73], v[72:73], v[56:57]
  v_pk_mul_f32 v[74:75], v[74:75], v[58:59]
  v_pk_mul_f32 v[76:77], v[76:77], v[60:61]
  v_pk_mul_f32 v[78:79], v[78:79], v[62:63]
  v_exp_f32 v72, v72
  v_exp_f32 v73, v73
  buffer_load_dwordx4 v[248:251], v17, s[60:63], s91 offen offset:2048 sc1
  v_exp_f32 v74, v74
  v_exp_f32 v75, v75
  v_exp_f32 v76, v76
  v_exp_f32 v77, v77
  v_exp_f32 v78, v78
  v_exp_f32 v79, v79
  v_pk_add_f32 v[72:73], v[72:73], 1.0 op_sel_hi:[1,0]
  buffer_load_dwordx4 v[188:191], v16, s[60:63], s91 offen offset:3072 sc1
  v_pk_add_f32 v[74:75], v[74:75], 1.0 op_sel_hi:[1,0]
  v_pk_add_f32 v[76:77], v[76:77], 1.0 op_sel_hi:[1,0]
  v_pk_add_f32 v[78:79], v[78:79], 1.0 op_sel_hi:[1,0]
  v_rcp_f32 v72, v72
  v_rcp_f32 v73, v73
  v_rcp_f32 v74, v74
  v_rcp_f32 v75, v75
  buffer_load_dwordx4 v[252:255], v17, s[60:63], s91 offen offset:3072 sc1
  v_rcp_f32 v76, v76
  v_rcp_f32 v77, v77
  v_rcp_f32 v78, v78
  v_rcp_f32 v79, v79
  v_pk_mul_f32 v[72:73], v[72:73], v[56:57]
  v_pk_mul_f32 v[74:75], v[74:75], v[58:59]
  v_pk_mul_f32 v[76:77], v[76:77], v[60:61]
  s_mov_b32 m0, 68864
  s_mov_b32 s70, 0
  buffer_load_dwordx4 v6, s[40:43], s70 offen lds
  v_pk_mul_f32 v[78:79], v[78:79], v[62:63]
  v_cvt_pk_bf16_f32 v124, v72, v73
  v_cvt_pk_bf16_f32 v125, v74, v75
  v_cvt_pk_bf16_f32 v126, v76, v77
  v_cvt_pk_bf16_f32 v127, v78, v79
  v_dot2_f32_bf16 v80, v120, v26, v80
  v_dot2_f32_bf16 v81, v120, v120, v81
  s_mov_b32 m0, 69888
  s_mov_b32 s70, 2048
  buffer_load_dwordx4 v6, s[40:43], s70 offen lds
  v_dot2_f32_bf16 v80, v121, v26, v80
  v_dot2_f32_bf16 v81, v121, v121, v81
  v_dot2_f32_bf16 v82, v122, v26, v82
  v_dot2_f32_bf16 v83, v122, v122, v83
  v_dot2_f32_bf16 v82, v123, v26, v82
  v_dot2_f32_bf16 v83, v123, v123, v83
  v_dot2_f32_bf16 v84, v124, v26, v84
  s_mov_b32 m0, 70912
  s_mov_b32 s70, 4096
  buffer_load_dwordx4 v6, s[40:43], s70 offen lds
  v_dot2_f32_bf16 v85, v124, v124, v85
  v_dot2_f32_bf16 v84, v125, v26, v84
  v_dot2_f32_bf16 v85, v125, v125, v85
  v_dot2_f32_bf16 v86, v126, v26, v86
  v_dot2_f32_bf16 v87, v126, v126, v87
  v_dot2_f32_bf16 v86, v127, v26, v86
  v_dot2_f32_bf16 v87, v127, v127, v87
  s_mov_b32 m0, 71936
  s_mov_b32 s70, 6144
  buffer_load_dwordx4 v6, s[40:43], s70 offen lds
  s_branch L_g1done
L_g1skip:
  buffer_load_dwordx4 v[168:171], v16, s[60:63], s90 offen offset:2048 sc1
  buffer_load_dwordx4 v[232:235], v17, s[60:63], s90 offen offset:2048 sc1
  buffer_load_dwordx4 v[172:175], v16, s[60:63], s90 offen offset:3072 sc1
  buffer_load_dwordx4 v[236:239], v17, s[60:63], s90 offen offset:3072 sc1
  buffer_load_dwordx4 v[176:179], v16, s[60:63], s91 offen offset:0 sc1
  buffer_load_dwordx4 v[240:243], v17, s[60:63], s91 offen offset:0 sc1
  buffer_load_dwordx4 v[180:183], v16, s[60:63], s91 offen offset:1024 sc1
  buffer_load_dwordx4 v[244:247], v17, s[60:63], s91 offen offset:1024 sc1
  buffer_load_dwordx4 v[184:187], v16, s[60:63], s91 offen offset:2048 sc1
  buffer_load_dwordx4 v[248:251], v17, s[60:63], s91 offen offset:2048 sc1
  buffer_load_dwordx4 v[188:191], v16, s[60:63], s91 offen offset:3072 sc1
  buffer_load_dwordx4 v[252:255], v17, s[60:63], s91 offen offset:3072 sc1
  s_mov_b32 m0, 68864
  s_mov_b32 s70, 0
  buffer_load_dwordx4 v6, s[40:43], s70 offen lds
  s_mov_b32 m0, 69888
  s_mov_b32 s70, 2048
  buffer_load_dwordx4 v6, s[40:43], s70 offen lds
  s_mov_b32 m0, 70912
  s_mov_b32 s70, 4096
  buffer_load_dwordx4 v6, s[40:43], s70 offen lds
  s_mov_b32 m0, 71936
  s_mov_b32 s70, 6144
  buffer_load_dwordx4 v6, s[40:43], s70 offen lds
L_g1done:
  ds_write_b64 v89, v[80:81]
  ds_write_b64 v90, v[82:83]
  ds_write_b64 v91, v[84:85]
  ds_write_b64 v92, v[86:87]
  s_waitcnt lgkmcnt(0)
  s_barrier
  ds_read_b64 v[72:73], v88 offset:0
  ds_read_b64 v[74:75], v88 offset:512
  ds_read_b64 v[76:77], v88 offset:1024
  ds_read_b64 v[78:79], v88 offset:1536
  s_waitcnt lgkmcnt(0)
  v_pk_add_f32 v[72:73], v[72:73], v[74:75]
  v_pk_add_f32 v[76:77], v[76:77], v[78:79]
  v_pk_add_f32 v[72:73], v[72:73], v[76:77]
  s_nop 1
  v_add_f32_dpp v72, v72, v72 quad_perm:[1,0,3,2] row_mask:0xf bank_mask:0xf
  v_add_f32_dpp v73, v73, v73 quad_perm:[1,0,3,2] row_mask:0xf bank_mask:0xf
  s_nop 0
  v_add_f32_dpp v72, v72, v72 quad_perm:[2,3,0,1] row_mask:0xf bank_mask:0xf
  v_add_f32_dpp v73, v73, v73 quad_perm:[2,3,0,1] row_mask:0xf bank_mask:0xf
  v_or_b32 v73, 1, v73
  s_mov_b32 exec_lo, 0x11111111
  s_mov_b32 exec_hi, 0x11111111
  buffer_store_dwordx2 v[72:73], v93, s[60:63], 0 offen sc1
  s_mov_b64 exec, -1
  s_waitcnt vmcnt(21)
  ds_read_b128 a[224:227], v10 offset:0
  ds_read_b128 a[228:231], v10 offset:2048
  ds_read_b128 a[232:235], v10 offset:4096
  ds_read_b128 a[236:239], v10 offset:6144
  ds_read_b128 a[240:243], v11 offset:0
  ds_read_b128 a[244:247], v11 offset:2048
  ds_read_b128 a[248:251], v11 offset:4096
  ds_read_b128 a[252:255], v11 offset:6144
  ds_read_b64_tr_b16 v[64:65], v18 offset:0
  ds_read_b64_tr_b16 v[66:67], v18 offset:512
  ds_read_b64_tr_b16 v[68:69], v19 offset:0
  ds_read_b64_tr_b16 v[70:71], v19 offset:512
  ds_read_b64_tr_b16 v[72:73], v20 offset:0
  ds_read_b64_tr_b16 v[74:75], v20 offset:512
  ds_read_b64_tr_b16 v[76:77], v21 offset:0
  ds_read_b64_tr_b16 v[78:79], v21 offset:512
  ds_read_b64_tr_b16 v[80:81], v18 offset:4096
  ds_read_b64_tr_b16 v[82:83], v18 offset:4608
  ds_read_b64_tr_b16 v[84:85], v19 offset:4096
  ds_read_b64_tr_b16 v[86:87], v19 offset:4608
  ds_read_b64_tr_b16 v[88:89], v20 offset:4096
  ds_read_b64_tr_b16 v[90:91], v20 offset:4608
  ds_read_b64_tr_b16 v[92:93], v21 offset:4096
  ds_read_b64_tr_b16 v[94:95], v21 offset:4608
  s_waitcnt lgkmcnt(8)
  v_mfma_f32_16x16x32_bf16 v[32:35], v[128:131], v[64:67], 0
  ds_read_b64_tr_b16 v[96:97], v18 offset:8192
  v_mfma_f32_16x16x32_bf16 v[36:39], v[128:131], v[68:71], 0
  ds_read_b64_tr_b16 v[98:99], v18 offset:8704
  s_add_u32 m0, s84, 8192
  s_add_u32 s74, s85, 384
  s_and_b32 s74, s74, 0x3ff
  v_add_u32 v12, s74, v8
  buffer_load_dwordx4 v12, s[32:35], s80 offen lds
  s_add_u32 m0, m0, 1024
  v_mfma_f32_16x16x32_bf16 v[40:43], v[128:131], v[72:75], 0
  ds_read_b64_tr_b16 v[100:101], v19 offset:8192
  v_mfma_f32_16x16x32_bf16 v[44:47], v[128:131], v[76:79], 0
  ds_read_b64_tr_b16 v[102:103], v19 offset:8704
  buffer_load_dwordx4 v12, s[32:35], s4 offen lds
  s_add_u32 m0, m0, 1024
  v_mfma_f32_16x16x32_bf16 v[48:51], v[192:195], v[64:67], 0
  ds_read_b64_tr_b16 v[104:105], v20 offset:8192
  v_mfma_f32_16x16x32_bf16 v[52:55], v[192:195], v[68:71], 0
  ds_read_b64_tr_b16 v[106:107], v20 offset:8704
  buffer_load_dwordx4 v12, s[32:35], s81 offen lds
  s_add_u32 m0, m0, 1024
  v_mfma_f32_16x16x32_bf16 v[56:59], v[192:195], v[72:75], 0
  ds_read_b64_tr_b16 v[108:109], v21 offset:8192
  v_mfma_f32_16x16x32_bf16 v[60:63], v[192:195], v[76:79], 0
  ds_read_b64_tr_b16 v[110:111], v21 offset:8704
  s_waitcnt lgkmcnt(8)
  v_mfma_f32_16x16x32_bf16 v[32:35], v[132:135], v[80:83], v[32:35]
  ds_read_b64_tr_b16 v[64:65], v18 offset:12288
  v_mfma_f32_16x16x32_bf16 v[36:39], v[132:135], v[84:87], v[36:39]
  ds_read_b64_tr_b16 v[66:67], v18 offset:12800
  buffer_load_dwordx4 v12, s[32:35], s5 offen lds
  s_add_u32 m0, m0, 1024
  v_mfma_f32_16x16x32_bf16 v[40:43], v[132:135], v[88:91], v[40:43]
  ds_read_b64_tr_b16 v[68:69], v19 offset:12288
  v_mfma_f32_16x16x32_bf16 v[44:47], v[132:135], v[92:95], v[44:47]
  ds_read_b64_tr_b16 v[70:71], v19 offset:12800
  buffer_load_dwordx4 v12, s[32:35], s82 offen lds
  s_add_u32 m0, m0, 1024
  v_mfma_f32_16x16x32_bf16 v[48:51], v[196:199], v[80:83], v[48:51]
  ds_read_b64_tr_b16 v[72:73], v20 offset:12288
  v_mfma_f32_16x16x32_bf16 v[52:55], v[196:199], v[84:87], v[52:55]
  ds_read_b64_tr_b16 v[74:75], v20 offset:12800
  buffer_load_dwordx4 v12, s[32:35], s6 offen lds
  s_add_u32 m0, m0, 1024
  v_mfma_f32_16x16x32_bf16 v[56:59], v[196:199], v[88:91], v[56:59]
  ds_read_b64_tr_b16 v[76:77], v21 offset:12288
  v_mfma_f32_16x16x32_bf16 v[60:63], v[196:199], v[92:95], v[60:63]
  ds_read_b64_tr_b16 v[78:79], v21 offset:12800
  s_waitcnt lgkmcnt(8)
  v_mfma_f32_16x16x32_bf16 v[32:35], v[136:139], v[96:99], v[32:35]
  ds_read_b64_tr_b16 v[80:81], v18 offset:16384
  v_mfma_f32_16x16x32_bf16 v[36:39], v[136:139], v[100:103], v[36:39]
  ds_read_b64_tr_b16 v[82:83], v18 offset:16896
  buffer_load_dwordx4 v12, s[32:35], s83 offen lds
  s_add_u32 m0, m0, 1024
  v_mfma_f32_16x16x32_bf16 v[40:43], v[136:139], v[104:107], v[40:43]
  ds_read_b64_tr_b16 v[84:85], v19 offset:16384
  v_mfma_f32_16x16x32_bf16 v[44:47], v[136:139], v[108:111], v[44:47]
  ds_read_b64_tr_b16 v[86:87], v19 offset:16896
  buffer_load_dwordx4 v12, s[32:35], s7 offen lds
  v_mfma_f32_16x16x32_bf16 v[48:51], v[200:203], v[96:99], v[48:51]
  ds_read_b64_tr_b16 v[88:89], v20 offset:16384
  v_mfma_f32_16x16x32_bf16 v[52:55], v[200:203], v[100:103], v[52:55]
  ds_read_b64_tr_b16 v[90:91], v20 offset:16896
  s_add_u32 m0, s84, 0
  s_add_u32 s74, s85, 640
  s_and_b32 s74, s74, 0x3ff
  v_add_u32 v12, s74, v8
  buffer_load_dwordx4 v12, s[32:35], s80 offen lds
  s_add_u32 m0, m0, 1024
  v_mfma_f32_16x16x32_bf16 v[56:59], v[200:203], v[104:107], v[56:59]
  ds_read_b64_tr_b16 v[92:93], v21 offset:16384
  v_mfma_f32_16x16x32_bf16 v[60:63], v[200:203], v[108:111], v[60:63]
  ds_read_b64_tr_b16 v[94:95], v21 offset:16896
  s_waitcnt lgkmcnt(8)
  v_mfma_f32_16x16x32_bf16 v[32:35], v[140:143], v[64:67], v[32:35]
  ds_read_b64_tr_b16 v[96:97], v18 offset:20480
  v_mfma_f32_16x16x32_bf16 v[36:39], v[140:143], v[68:71], v[36:39]
  ds_read_b64_tr_b16 v[98:99], v18 offset:20992
  buffer_load_dwordx4 v12, s[32:35], s4 offen lds
  s_add_u32 m0, m0, 1024
  v_mfma_f32_16x16x32_bf16 v[40:43], v[140:143], v[72:75], v[40:43]
  ds_read_b64_tr_b16 v[100:101], v19 offset:20480
  v_mfma_f32_16x16x32_bf16 v[44:47], v[140:143], v[76:79], v[44:47]
  ds_read_b64_tr_b16 v[102:103], v19 offset:20992
  buffer_load_dwordx4 v12, s[32:35], s81 offen lds
  s_add_u32 m0, m0, 1024
  v_mfma_f32_16x16x32_bf16 v[48:51], v[204:207], v[64:67], v[48:51]
  ds_read_b64_tr_b16 v[104:105], v20 offset:20480
  v_mfma_f32_16x16x32_bf16 v[52:55], v[204:207], v[68:71], v[52:55]
  ds_read_b64_tr_b16 v[106:107], v20 offset:20992
  buffer_load_dwordx4 v12, s[32:35], s5 offen lds
  s_add_u32 m0, m0, 1024
  v_mfma_f32_16x16x32_bf16 v[56:59], v[204:207], v[72:75], v[56:59]
  ds_read_b64_tr_b16 v[108:109], v21 offset:20480
  v_mfma_f32_16x16x32_bf16 v[60:63], v[204:207], v[76:79], v[60:63]
  ds_read_b64_tr_b16 v[110:111], v21 offset:20992
  s_waitcnt lgkmcnt(8)
  v_mfma_f32_16x16x32_bf16 v[32:35], v[144:147], v[80:83], v[32:35]
  ds_read_b64_tr_b16 v[64:65], v18 offset:24576
  v_mfma_f32_16x16x32_bf16 v[36:39], v[144:147], v[84:87], v[36:39]
  ds_read_b64_tr_b16 v[66:67], v18 offset:25088
  buffer_load_dwordx4 v12, s[32:35], s82 offen lds
  s_add_u32 m0, m0, 1024
  v_mfma_f32_16x16x32_bf16 v[40:43], v[144:147], v[88:91], v[40:43]
  ds_read_b64_tr_b16 v[68:69], v19 offset:24576
  v_mfma_f32_16x16x32_bf16 v[44:47], v[144:147], v[92:95], v[44:47]
  ds_read_b64_tr_b16 v[70:71], v19 offset:25088
  buffer_load_dwordx4 v12, s[32:35], s6 offen lds
  s_add_u32 m0, m0, 1024
  v_mfma_f32_16x16x32_bf16 v[48:51], v[208:211], v[80:83], v[48:51]
  ds_read_b64_tr_b16 v[72:73], v20 offset:24576
  v_mfma_f32_16x16x32_bf16 v[52:55], v[208:211], v[84:87], v[52:55]
  ds_read_b64_tr_b16 v[74:75], v20 offset:25088
  buffer_load_dwordx4 v12, s[32:35], s83 offen lds
  s_add_u32 m0, m0, 1024
  v_mfma_f32_16x16x32_bf16 v[56:59], v[208:211], v[88:91], v[56:59]
  ds_read_b64_tr_b16 v[76:77], v21 offset:24576
  v_mfma_f32_16x16x32_bf16 v[60:63], v[208:211], v[92:95], v[60:63]
  ds_read_b64_tr_b16 v[78:79], v21 offset:25088
  s_waitcnt lgkmcnt(8)
  v_mfma_f32_16x16x32_bf16 v[32:35], v[148:151], v[96:99], v[32:35]
  ds_read_b64_tr_b16 v[80:81], v18 offset:28672
  v_mfma_f32_16x16x32_bf16 v[36:39], v[148:151], v[100:103], v[36:39]
  ds_read_b64_tr_b16 v[82:83], v18 offset:29184
  buffer_load_dwordx4 v12, s[32:35], s7 offen lds
  v_mfma_f32_16x16x32_bf16 v[40:43], v[148:151], v[104:107], v[40:43]
  ds_read_b64_tr_b16 v[84:85], v19 offset:28672
  v_mfma_f32_16x16x32_bf16 v[44:47], v[148:151], v[108:111], v[44:47]
  ds_read_b64_tr_b16 v[86:87], v19 offset:29184
  v_mfma_f32_16x16x32_bf16 v[48:51], v[212:215], v[96:99], v[48:51]
  ds_read_b64_tr_b16 v[88:89], v20 offset:28672
  v_mfma_f32_16x16x32_bf16 v[52:55], v[212:215], v[100:103], v[52:55]
  ds_read_b64_tr_b16 v[90:91], v20 offset:29184
  v_mfma_f32_16x16x32_bf16 v[56:59], v[212:215], v[104:107], v[56:59]
  ds_read_b64_tr_b16 v[92:93], v21 offset:28672
  v_mfma_f32_16x16x32_bf16 v[60:63], v[212:215], v[108:111], v[60:63]
  ds_read_b64_tr_b16 v[94:95], v21 offset:29184
  s_waitcnt lgkmcnt(8)
  v_mfma_f32_16x16x32_bf16 v[32:35], v[152:155], v[64:67], v[32:35]
  v_mfma_f32_16x16x32_bf16 v[36:39], v[152:155], v[68:71], v[36:39]
  v_mfma_f32_16x16x32_bf16 v[40:43], v[152:155], v[72:75], v[40:43]
  v_mfma_f32_16x16x32_bf16 v[44:47], v[152:155], v[76:79], v[44:47]
  v_mfma_f32_16x16x32_bf16 v[48:51], v[216:219], v[64:67], v[48:51]
  v_mfma_f32_16x16x32_bf16 v[52:55], v[216:219], v[68:71], v[52:55]
  v_mfma_f32_16x16x32_bf16 v[56:59], v[216:219], v[72:75], v[56:59]
  v_mfma_f32_16x16x32_bf16 v[60:63], v[216:219], v[76:79], v[60:63]
  s_waitcnt lgkmcnt(0)
  v_mfma_f32_16x16x32_bf16 v[32:35], v[156:159], v[80:83], v[32:35]
  v_mfma_f32_16x16x32_bf16 v[36:39], v[156:159], v[84:87], v[36:39]
  v_mfma_f32_16x16x32_bf16 v[40:43], v[156:159], v[88:91], v[40:43]
  v_mfma_f32_16x16x32_bf16 v[44:47], v[156:159], v[92:95], v[44:47]
  v_mfma_f32_16x16x32_bf16 v[48:51], v[220:223], v[80:83], v[48:51]
  v_mfma_f32_16x16x32_bf16 v[52:55], v[220:223], v[84:87], v[52:55]
  v_mfma_f32_16x16x32_bf16 v[56:59], v[220:223], v[88:91], v[56:59]
  v_mfma_f32_16x16x32_bf16 v[60:63], v[220:223], v[92:95], v[60:63]
  s_lshl_b32 s70, s67, 12
  s_add_u32 s70, s70, 65536
  v_and_b32 v88, 3, v0
  v_lshl_add_u32 v88, v88, 10, v5
  v_add_u32 v88, s70, v88
  s_mov_b32 s77, 0
  buffer_load_dwordx2 v[72:73], v88, s[60:63], 0 offen sc1
  buffer_load_dwordx2 v[74:75], v88, s[60:63], 0 offen offset:512 sc1
  s_mul_i32 s71, s66, 4608
  s_add_u32 s71, s71, 65536
  s_sub_u32 s70, s71, 1400832
  v_lshl_add_u32 v80, v3, 3, s70
  v_mad_u32_u24 v89, v22, 9, v80
  v_mad_u32_u24 v90, v23, 9, v80
  v_mad_u32_u24 v91, v24, 9, v80
  v_mad_u32_u24 v92, v25, 9, v80
  v_lshrrev_b32 v93, 2, v2
  v_lshl_add_u32 v93, v3, 3, v93
  v_mul_u32_u24 v93, 72, v93
  v_and_b32 v94, 3, v2
  v_lshl_add_u32 v93, v94, 3, v93
  v_add_u32 v93, s71, v93
  s_mul_i32 s70, s68, 458752
  s_lshl_b32 s71, s66, 17
  s_add_u32 s70, s70, s71
  s_lshl_b32 s71, s67, 11
  s_add_u32 s70, s70, s71
  s_add_u32 s70, s70, 9437184
  v_add_u32 v94, s70, v4
  s_add_u32 s70, s70, 65536
  s_add_u32 s70, s70, s88
  v_add_u32 v95, s70, v4
  v_add_u32 v81, 156160, v5
  s_branch L_grc
L_gr:
  buffer_load_dwordx2 v[72:73], v88, s[60:63], 0 offen sc1
  buffer_load_dwordx2 v[74:75], v88, s[60:63], 0 offen offset:512 sc1
L_grc:
  s_waitcnt vmcnt(0)
  v_min_u32 v76, v73, v75
  v_cmp_eq_u32 vcc, 0, v76
  s_nop 0
  s_cbranch_vccz L_grd
  s_add_u32 s77, s77, 1
  s_cmp_lt_u32 s77, 200000
  s_cbranch_scc1 L_gr
L_grd:
  ds_read_b128 a[96:99], v10 offset:8192
  ds_read_b128 a[100:103], v10 offset:10240
  ds_read_b128 a[104:107], v10 offset:12288
  ds_read_b128 a[108:111], v10 offset:14336
  ds_read_b128 a[112:115], v11 offset:8192
  ds_read_b128 a[116:119], v11 offset:10240
  ds_read_b128 a[120:123], v11 offset:12288
  ds_read_b128 a[124:127], v11 offset:14336
  ds_read_b128 a[160:163], v10 offset:0
  ds_read_b128 a[164:167], v10 offset:2048
  ds_read_b128 a[168:171], v10 offset:4096
  ds_read_b128 a[172:175], v10 offset:6144
  ds_read_b128 a[176:179], v11 offset:0
  ds_read_b128 a[180:183], v11 offset:2048
  ds_read_b128 a[184:187], v11 offset:4096
  ds_read_b128 a[188:191], v11 offset:6144
  v_pk_add_f32 v[72:73], v[72:73], v[74:75]
  s_nop 1
  v_add_f32_dpp v72, v72, v72 quad_perm:[1,0,3,2] row_mask:0xf bank_mask:0xf
  v_add_f32_dpp v73, v73, v73 quad_perm:[1,0,3,2] row_mask:0xf bank_mask:0xf
  s_nop 0
  v_add_f32_dpp v72, v72, v72 quad_perm:[2,3,0,1] row_mask:0xf bank_mask:0xf
  v_add_f32_dpp v73, v73, v73 quad_perm:[2,3,0,1] row_mask:0xf bank_mask:0xf
  v_mul_f32 v72, 0xba924925, v72
  v_mul_f32 v74, v72, v72
  v_mov_b32 v75, 0x3a924925
  v_fma_f32 v73, v73, v75, -v74
  v_max_f32 v73, 0, v73
  v_add_f32 v73, 0x3727c5ac, v73
  v_rsq_f32 v73, v73
  s_nop 0
  v_mul_f32 v72, v72, v73
  ds_write_b64 v81, v[72:73]
  s_waitcnt lgkmcnt(0)
  s_barrier
  ds_read_b64 v[64:65], v22 offset:512
  ds_read_b64 v[66:67], v23 offset:512
  ds_read_b64 v[68:69], v24 offset:512
  ds_read_b64 v[70:71], v25 offset:512
  s_waitcnt lgkmcnt(0)
  v_lshlrev_b32 v72, 16, v112
  v_and_b32 v73, s69, v112
  v_lshlrev_b32 v74, 16, v113
  v_and_b32 v75, s69, v113
  v_pk_fma_f32 v[72:73], v[72:73], v[64:65], v[64:65] op_sel:[0,1,0] op_sel_hi:[1,1,0]
  v_pk_fma_f32 v[74:75], v[74:75], v[64:65], v[64:65] op_sel:[0,1,0] op_sel_hi:[1,1,0]
  v_cvt_pk_bf16_f32 v112, v72, v73
  v_cvt_pk_bf16_f32 v113, v74, v75
  ds_write_b64 v89, v[112:113] offset:0
  v_lshlrev_b32 v76, 16, v114
  v_and_b32 v77, s69, v114
  v_lshlrev_b32 v78, 16, v115
  v_and_b32 v79, s69, v115
  v_pk_fma_f32 v[76:77], v[76:77], v[66:67], v[66:67] op_sel:[0,1,0] op_sel_hi:[1,1,0]
  v_pk_fma_f32 v[78:79], v[78:79], v[66:67], v[66:67] op_sel:[0,1,0] op_sel_hi:[1,1,0]
  v_cvt_pk_bf16_f32 v114, v76, v77
  v_cvt_pk_bf16_f32 v115, v78, v79
  ds_write_b64 v90, v[114:115] offset:0
  v_lshlrev_b32 v72, 16, v116
  v_and_b32 v73, s69, v116
  v_lshlrev_b32 v74, 16, v117
  v_and_b32 v75, s69, v117
  v_pk_fma_f32 v[72:73], v[72:73], v[68:69], v[68:69] op_sel:[0,1,0] op_sel_hi:[1,1,0]
  v_pk_fma_f32 v[74:75], v[74:75], v[68:69], v[68:69] op_sel:[0,1,0] op_sel_hi:[1,1,0]
  v_cvt_pk_bf16_f32 v116, v72, v73
  v_cvt_pk_bf16_f32 v117, v74, v75
  ds_write_b64 v91, v[116:117] offset:0
  v_lshlrev_b32 v76, 16, v118
  v_and_b32 v77, s69, v118
  v_lshlrev_b32 v78, 16, v119
  v_and_b32 v79, s69, v119
  v_pk_fma_f32 v[76:77], v[76:77], v[70:71], v[70:71] op_sel:[0,1,0] op_sel_hi:[1,1,0]
  v_pk_fma_f32 v[78:79], v[78:79], v[70:71], v[70:71] op_sel:[0,1,0] op_sel_hi:[1,1,0]
  v_cvt_pk_bf16_f32 v118, v76, v77
  v_cvt_pk_bf16_f32 v119, v78, v79
  ds_write_b64 v92, v[118:119] offset:0
  v_lshlrev_b32 v72, 16, v120
  v_and_b32 v73, s69, v120
  v_lshlrev_b32 v74, 16, v121
  v_and_b32 v75, s69, v121
  v_pk_fma_f32 v[72:73], v[72:73], v[64:65], v[64:65] op_sel:[0,1,0] op_sel_hi:[1,1,0]
  v_pk_fma_f32 v[74:75], v[74:75], v[64:65], v[64:65] op_sel:[0,1,0] op_sel_hi:[1,1,0]
  v_cvt_pk_bf16_f32 v120, v72, v73
  v_cvt_pk_bf16_f32 v121, v74, v75
  ds_write_b64 v89, v[120:121] offset:32
  v_lshlrev_b32 v76, 16, v122
  v_and_b32 v77, s69, v122
  v_lshlrev_b32 v78, 16, v123
  v_and_b32 v79, s69, v123
  v_pk_fma_f32 v[76:77], v[76:77], v[66:67], v[66:67] op_sel:[0,1,0] op_sel_hi:[1,1,0]
  v_pk_fma_f32 v[78:79], v[78:79], v[66:67], v[66:67] op_sel:[0,1,0] op_sel_hi:[1,1,0]
  v_cvt_pk_bf16_f32 v122, v76, v77
  v_cvt_pk_bf16_f32 v123, v78, v79
  ds_write_b64 v90, v[122:123] offset:32
  v_lshlrev_b32 v72, 16, v124
  v_and_b32 v73, s69, v124
  v_lshlrev_b32 v74, 16, v125
  v_and_b32 v75, s69, v125
  v_pk_fma_f32 v[72:73], v[72:73], v[68:69], v[68:69] op_sel:[0,1,0] op_sel_hi:[1,1,0]
  v_pk_fma_f32 v[74:75], v[74:75], v[68:69], v[68:69] op_sel:[0,1,0] op_sel_hi:[1,1,0]
  v_cvt_pk_bf16_f32 v124, v72, v73
  v_cvt_pk_bf16_f32 v125, v74, v75
  ds_write_b64 v91, v[124:125] offset:32
  v_lshlrev_b32 v76, 16, v126
  v_and_b32 v77, s69, v126
  v_lshlrev_b32 v78, 16, v127
  v_and_b32 v79, s69, v127
  v_pk_fma_f32 v[76:77], v[76:77], v[70:71], v[70:71] op_sel:[0,1,0] op_sel_hi:[1,1,0]
  v_pk_fma_f32 v[78:79], v[78:79], v[70:71], v[70:71] op_sel:[0,1,0] op_sel_hi:[1,1,0]
  v_cvt_pk_bf16_f32 v126, v76, v77
  v_cvt_pk_bf16_f32 v127, v78, v79
  ds_write_b64 v92, v[126:127] offset:32
  s_waitcnt lgkmcnt(0)
  ds_read_b64_tr_b16 v[128:129], v93 offset:0
  ds_read_b64_tr_b16 v[130:131], v93 offset:288
  ds_read_b64_tr_b16 v[132:133], v93 offset:2304
  ds_read_b64_tr_b16 v[134:135], v93 offset:2592
  ds_read_b64_tr_b16 v[136:137], v93 offset:32
  ds_read_b64_tr_b16 v[138:139], v93 offset:320
  ds_read_b64_tr_b16 v[140:141], v93 offset:2336
  ds_read_b64_tr_b16 v[142:143], v93 offset:2624
  s_waitcnt lgkmcnt(6)
  buffer_store_dwordx4 v[128:131], v94, s[60:63], 0 offen offset:0 sc1
  s_waitcnt lgkmcnt(4)
  buffer_store_dwordx4 v[132:135], v94, s[60:63], 0 offen offset:1024 sc1
  s_waitcnt lgkmcnt(2)
  buffer_store_dwordx4 v[136:139], v95, s[60:63], 0 offen offset:0 sc1
  s_waitcnt lgkmcnt(0)
  buffer_store_dwordx4 v[140:143], v95, s[60:63], 0 offen offset:1024 sc1
  s_waitcnt vmcnt(0)
  s_waitcnt lgkmcnt(0)
  s_barrier
  s_cmp_eq_u32 s66, 0
  s_cbranch_scc0 L_ow_26
  s_lshl_b32 s70, s68, 2
  s_lshr_b32 s71, s67, 3
  s_add_u32 s70, s70, s71
  s_lshl_b32 s70, s70, 8
  s_add_u32 s70, s70, 10240
  v_mov_b32 v72, s70
  v_mov_b32 v73, 1
  s_mov_b64 exec, 1
  buffer_atomic_add v73, v72, s[60:63], 0 offen sc1
  s_mov_b64 exec, -1
L_ow_26:
  v_lshrrev_b32 v6, 3, v1
  v_lshrrev_b32 v7, 1, v6
  v_and_b32 v7, 1, v7
  s_and_b32 s70, s66, 1
  s_lshl_b32 s70, s70, 1
  v_or_b32 v7, s70, v7
  v_bfe_u32 v13, v1, 1, 2
  v_xor_b32 v7, v7, v13
  v_lshlrev_b32 v7, 5, v7
  v_and_b32 v13, 1, v1
  v_lshl_add_u32 v7, v13, 4, v7
  v_lshl_add_u32 v7, v6, 10, v7
  s_lshl_b32 s70, s66, 13
  s_lshl_b32 s71, s68, 7
  s_add_u32 s70, s70, s71
  v_add_u32 v7, s70, v7
  s_lshl_b32 s89, s66, 10
  s_cmp_ge_u32 s66, 2
  s_cselect_b32 s70, 98304, 0
  v_add_u32 v6, s70, v7
  ds_read_b64_tr_b16 v[96:97], v18 offset:32768
  ds_read_b64_tr_b16 v[98:99], v18 offset:33280
  ds_read_b64_tr_b16 v[100:101], v19 offset:32768
  ds_read_b64_tr_b16 v[102:103], v19 offset:33280
  ds_read_b64_tr_b16 v[104:105], v20 offset:32768
  ds_read_b64_tr_b16 v[106:107], v20 offset:33280
  ds_read_b64_tr_b16 v[108:109], v21 offset:32768
  ds_read_b64_tr_b16 v[110:111], v21 offset:33280
  ds_read_b64_tr_b16 v[64:65], v18 offset:36864
  ds_read_b64_tr_b16 v[66:67], v18 offset:37376
  ds_read_b64_tr_b16 v[68:69], v19 offset:36864
  ds_read_b64_tr_b16 v[70:71], v19 offset:37376
  ds_read_b64_tr_b16 v[72:73], v20 offset:36864
  ds_read_b64_tr_b16 v[74:75], v20 offset:37376
  ds_read_b64_tr_b16 v[76:77], v21 offset:36864
  ds_read_b64_tr_b16 v[78:79], v21 offset:37376
  s_waitcnt lgkmcnt(8)
  v_mfma_f32_16x16x32_bf16 v[32:35], v[160:163], v[96:99], v[32:35]
  ds_read_b64_tr_b16 v[80:81], v18 offset:40960
  v_mfma_f32_16x16x32_bf16 v[36:39], v[160:163], v[100:103], v[36:39]
  ds_read_b64_tr_b16 v[82:83], v18 offset:41472
  s_add_u32 m0, s89, 65536
  s_mov_b32 s90, 606208
  buffer_load_dwordx4 v7, s[40:43], s90 offen lds
  v_mfma_f32_16x16x32_bf16 v[40:43], v[160:163], v[104:107], v[40:43]
  ds_read_b64_tr_b16 v[84:85], v19 offset:40960
  v_mfma_f32_16x16x32_bf16 v[44:47], v[160:163], v[108:111], v[44:47]
  ds_read_b64_tr_b16 v[86:87], v19 offset:41472
  s_add_u32 m0, s89, 69632
  s_mov_b32 s90, 638976
  buffer_load_dwordx4 v7, s[40:43], s90 offen lds
  v_mfma_f32_16x16x32_bf16 v[48:51], v[224:227], v[96:99], v[48:51]
  ds_read_b64_tr_b16 v[88:89], v20 offset:40960
  v_mfma_f32_16x16x32_bf16 v[52:55], v[224:227], v[100:103], v[52:55]
  ds_read_b64_tr_b16 v[90:91], v20 offset:41472
  v_mfma_f32_16x16x32_bf16 v[56:59], v[224:227], v[104:107], v[56:59]
  ds_read_b64_tr_b16 v[92:93], v21 offset:40960
  v_mfma_f32_16x16x32_bf16 v[60:63], v[224:227], v[108:111], v[60:63]
  ds_read_b64_tr_b16 v[94:95], v21 offset:41472
  s_waitcnt lgkmcnt(8)
  v_mfma_f32_16x16x32_bf16 v[32:35], v[164:167], v[64:67], v[32:35]
  ds_read_b64_tr_b16 v[96:97], v18 offset:45056
  v_mfma_f32_16x16x32_bf16 v[36:39], v[164:167], v[68:71], v[36:39]
  ds_read_b64_tr_b16 v[98:99], v18 offset:45568
  s_add_u32 m0, s89, 73728
  s_mov_b32 s90, 688128
  buffer_load_dwordx4 v7, s[40:43], s90 offen lds
  v_mfma_f32_16x16x32_bf16 v[40:43], v[164:167], v[72:75], v[40:43]
  ds_read_b64_tr_b16 v[100:101], v19 offset:45056
  v_mfma_f32_16x16x32_bf16 v[44:47], v[164:167], v[76:79], v[44:47]
  ds_read_b64_tr_b16 v[102:103], v19 offset:45568
  s_add_u32 m0, s89, 77824
  s_mov_b32 s90, 720896
  buffer_load_dwordx4 v7, s[40:43], s90 offen lds
  v_mfma_f32_16x16x32_bf16 v[48:51], v[228:231], v[64:67], v[48:51]
  ds_read_b64_tr_b16 v[104:105], v20 offset:45056
  v_mfma_f32_16x16x32_bf16 v[52:55], v[228:231], v[68:71], v[52:55]
  ds_read_b64_tr_b16 v[106:107], v20 offset:45568
  v_mfma_f32_16x16x32_bf16 v[56:59], v[228:231], v[72:75], v[56:59]
  ds_read_b64_tr_b16 v[108:109], v21 offset:45056
  v_mfma_f32_16x16x32_bf16 v[60:63], v[228:231], v[76:79], v[60:63]
  ds_read_b64_tr_b16 v[110:111], v21 offset:45568
  s_waitcnt lgkmcnt(8)
  v_mfma_f32_16x16x32_bf16 v[32:35], v[168:171], v[80:83], v[32:35]
  ds_read_b64_tr_b16 v[64:65], v18 offset:49152
  v_mfma_f32_16x16x32_bf16 v[36:39], v[168:171], v[84:87], v[36:39]
  ds_read_b64_tr_b16 v[66:67], v18 offset:49664
  s_add_u32 m0, s89, 81920
  s_mov_b32 s90, 753664
  buffer_load_dwordx4 v7, s[40:43], s90 offen lds
  v_mfma_f32_16x16x32_bf16 v[40:43], v[168:171], v[88:91], v[40:43]
  ds_read_b64_tr_b16 v[68:69], v19 offset:49152
  v_mfma_f32_16x16x32_bf16 v[44:47], v[168:171], v[92:95], v[44:47]
  ds_read_b64_tr_b16 v[70:71], v19 offset:49664
  s_add_u32 m0, s89, 86016
  s_mov_b32 s90, 802816
  buffer_load_dwordx4 v7, s[40:43], s90 offen lds
  v_mfma_f32_16x16x32_bf16 v[48:51], v[232:235], v[80:83], v[48:51]
  ds_read_b64_tr_b16 v[72:73], v20 offset:49152
  v_mfma_f32_16x16x32_bf16 v[52:55], v[232:235], v[84:87], v[52:55]
  ds_read_b64_tr_b16 v[74:75], v20 offset:49664
  v_mfma_f32_16x16x32_bf16 v[56:59], v[232:235], v[88:91], v[56:59]
  ds_read_b64_tr_b16 v[76:77], v21 offset:49152
  v_mfma_f32_16x16x32_bf16 v[60:63], v[232:235], v[92:95], v[60:63]
  ds_read_b64_tr_b16 v[78:79], v21 offset:49664
  s_waitcnt lgkmcnt(8)
  v_mfma_f32_16x16x32_bf16 v[32:35], v[172:175], v[96:99], v[32:35]
  ds_read_b64_tr_b16 v[80:81], v18 offset:53248
  v_mfma_f32_16x16x32_bf16 v[36:39], v[172:175], v[100:103], v[36:39]
  ds_read_b64_tr_b16 v[82:83], v18 offset:53760
  s_add_u32 m0, s89, 90112
  s_mov_b32 s90, 835584
  buffer_load_dwordx4 v7, s[40:43], s90 offen lds
  v_mfma_f32_16x16x32_bf16 v[40:43], v[172:175], v[104:107], v[40:43]
  ds_read_b64_tr_b16 v[84:85], v19 offset:53248
  v_mfma_f32_16x16x32_bf16 v[44:47], v[172:175], v[108:111], v[44:47]
  ds_read_b64_tr_b16 v[86:87], v19 offset:53760
  s_add_u32 m0, s89, 94208
  s_mov_b32 s90, 868352
  buffer_load_dwordx4 v7, s[40:43], s90 offen lds
  v_mfma_f32_16x16x32_bf16 v[48:51], v[236:239], v[96:99], v[48:51]
  ds_read_b64_tr_b16 v[88:89], v20 offset:53248
  v_mfma_f32_16x16x32_bf16 v[52:55], v[236:239], v[100:103], v[52:55]
  ds_read_b64_tr_b16 v[90:91], v20 offset:53760
  v_mfma_f32_16x16x32_bf16 v[56:59], v[236:239], v[104:107], v[56:59]
  ds_read_b64_tr_b16 v[92:93], v21 offset:53248
  v_mfma_f32_16x16x32_bf16 v[60:63], v[236:239], v[108:111], v[60:63]
  ds_read_b64_tr_b16 v[94:95], v21 offset:53760
  s_waitcnt lgkmcnt(8)
  v_mfma_f32_16x16x32_bf16 v[32:35], v[176:179], v[64:67], v[32:35]
  ds_read_b64_tr_b16 v[96:97], v18 offset:57344
  v_mfma_f32_16x16x32_bf16 v[36:39], v[176:179], v[68:71], v[36:39]
  ds_read_b64_tr_b16 v[98:99], v18 offset:57856
  s_add_u32 m0, s89, 98304
  s_mov_b32 s90, 98304
  buffer_load_dwordx4 v6, s[40:43], s90 offen lds
  v_mfma_f32_16x16x32_bf16 v[40:43], v[176:179], v[72:75], v[40:43]
  ds_read_b64_tr_b16 v[100:101], v19 offset:57344
  v_mfma_f32_16x16x32_bf16 v[44:47], v[176:179], v[76:79], v[44:47]
  ds_read_b64_tr_b16 v[102:103], v19 offset:57856
  s_add_u32 m0, s89, 102400
  s_mov_b32 s90, 327680
  buffer_load_dwordx4 v6, s[40:43], s90 offen lds
  v_mfma_f32_16x16x32_bf16 v[48:51], v[240:243], v[64:67], v[48:51]
  ds_read_b64_tr_b16 v[104:105], v20 offset:57344
  v_mfma_f32_16x16x32_bf16 v[52:55], v[240:243], v[68:71], v[52:55]
  ds_read_b64_tr_b16 v[106:107], v20 offset:57856
  v_mfma_f32_16x16x32_bf16 v[56:59], v[240:243], v[72:75], v[56:59]
  ds_read_b64_tr_b16 v[108:109], v21 offset:57344
  v_mfma_f32_16x16x32_bf16 v[60:63], v[240:243], v[76:79], v[60:63]
  ds_read_b64_tr_b16 v[110:111], v21 offset:57856
  s_waitcnt lgkmcnt(8)
  v_mfma_f32_16x16x32_bf16 v[32:35], v[180:183], v[80:83], v[32:35]
  ds_read_b64_tr_b16 v[64:65], v18 offset:61440
  v_mfma_f32_16x16x32_bf16 v[36:39], v[180:183], v[84:87], v[36:39]
  ds_read_b64_tr_b16 v[66:67], v18 offset:61952
  s_add_u32 m0, s89, 106496
  s_mov_b32 s90, 557056
  buffer_load_dwordx4 v6, s[40:43], s90 offen lds
  v_mfma_f32_16x16x32_bf16 v[40:43], v[180:183], v[88:91], v[40:43]
  ds_read_b64_tr_b16 v[68:69], v19 offset:61440
  v_mfma_f32_16x16x32_bf16 v[44:47], v[180:183], v[92:95], v[44:47]
  ds_read_b64_tr_b16 v[70:71], v19 offset:61952
  s_add_u32 m0, s89, 110592
  s_mov_b32 s90, 786432
  buffer_load_dwordx4 v6, s[40:43], s90 offen lds
  v_mfma_f32_16x16x32_bf16 v[48:51], v[244:247], v[80:83], v[48:51]
  ds_read_b64_tr_b16 v[72:73], v20 offset:61440
  v_mfma_f32_16x16x32_bf16 v[52:55], v[244:247], v[84:87], v[52:55]
  ds_read_b64_tr_b16 v[74:75], v20 offset:61952
  v_mfma_f32_16x16x32_bf16 v[56:59], v[244:247], v[88:91], v[56:59]
  ds_read_b64_tr_b16 v[76:77], v21 offset:61440
  v_mfma_f32_16x16x32_bf16 v[60:63], v[244:247], v[92:95], v[60:63]
  ds_read_b64_tr_b16 v[78:79], v21 offset:61952
  s_waitcnt lgkmcnt(8)
  v_mfma_f32_16x16x32_bf16 v[32:35], v[184:187], v[96:99], v[32:35]
  v_mfma_f32_16x16x32_bf16 v[36:39], v[184:187], v[100:103], v[36:39]
  v_mfma_f32_16x16x32_bf16 v[40:43], v[184:187], v[104:107], v[40:43]
  v_mfma_f32_16x16x32_bf16 v[44:47], v[184:187], v[108:111], v[44:47]
  v_mfma_f32_16x16x32_bf16 v[48:51], v[248:251], v[96:99], v[48:51]
  v_mfma_f32_16x16x32_bf16 v[52:55], v[248:251], v[100:103], v[52:55]
  v_mfma_f32_16x16x32_bf16 v[56:59], v[248:251], v[104:107], v[56:59]
  v_mfma_f32_16x16x32_bf16 v[60:63], v[248:251], v[108:111], v[60:63]
  s_waitcnt lgkmcnt(0)
  v_mfma_f32_16x16x32_bf16 v[32:35], v[188:191], v[64:67], v[32:35]
  v_mfma_f32_16x16x32_bf16 v[36:39], v[188:191], v[68:71], v[36:39]
  v_mfma_f32_16x16x32_bf16 v[40:43], v[188:191], v[72:75], v[40:43]
  v_mfma_f32_16x16x32_bf16 v[44:47], v[188:191], v[76:79], v[44:47]
  v_mfma_f32_16x16x32_bf16 v[48:51], v[252:255], v[64:67], v[48:51]
  v_mfma_f32_16x16x32_bf16 v[52:55], v[252:255], v[68:71], v[52:55]
  v_mfma_f32_16x16x32_bf16 v[56:59], v[252:255], v[72:75], v[56:59]
  v_mfma_f32_16x16x32_bf16 v[60:63], v[252:255], v[76:79], v[60:63]
  v_lshrrev_b32 v76, 2, v2
  v_lshl_add_u32 v76, v3, 2, v76
  v_lshlrev_b32 v76, 7, v76
  v_and_b32 v77, 1, v2
  v_lshl_add_u32 v76, v77, 3, v76
  v_bfe_u32 v77, v2, 1, 1
  v_lshl_add_u32 v76, v77, 6, v76
  v_lshrrev_b32 v77, 3, v2
  v_and_b32 v78, 2, v3
  v_or_b32 v77, v77, v78
  v_xor_b32 v77, s66, v77
  v_lshl_add_u32 v76, v77, 4, v76
  s_lshl_b32 s70, s68, 13
  v_add_u32 v76, s70, v76
  ds_read_b64_tr_b16 v[240:241], v76 offset:0
  ds_read_b64_tr_b16 v[242:243], v76 offset:2048
  ds_read_b64_tr_b16 v[244:245], v76 offset:4096
  ds_read_b64_tr_b16 v[246:247], v76 offset:6144
  ds_read_b128 v[128:131], v31 offset:256
  ds_read_b128 v[132:135], v31 offset:384
  ds_read_b128 v[136:139], v31 offset:320
  ds_read_b128 v[140:143], v31 offset:448
  ds_read_b64 v[64:65], v22
  ds_read_b64 v[66:67], v23
  ds_read_b64 v[68:69], v24
  ds_read_b64 v[70:71], v25
  s_waitcnt lgkmcnt(0)
  s_lshl_b32 s72, s66, 10
  s_add_u32 s72, s72, 114688
  v_lshl_add_u32 v88, v1, 3, s72
  v_bfe_u32 v89, v22, 7, 2
  v_mul_u32_u24 v89, 3584, v89
  v_add_u32 v89, v89, v88
  v_bfe_u32 v90, v23, 7, 2
  v_mul_u32_u24 v90, 3584, v90
  v_add_u32 v90, v90, v88
  v_bfe_u32 v91, v24, 7, 2
  v_mul_u32_u24 v91, 3584, v91
  v_add_u32 v91, v91, v88
  v_bfe_u32 v92, v25, 7, 2
  v_mul_u32_u24 v92, 3584, v92
  v_add_u32 v92, v92, v88
  s_lshl_b32 s70, s67, 7
  s_lshl_b32 s72, s66, 5
  s_add_u32 s70, s70, s72
  v_lshl_add_u32 v29, v2, 1, s70
  s_lshl_b32 s70, s68, 8
  s_add_u32 s70, s70, 534528
  v_lshl_add_u32 v30, v1, 2, s70
  buffer_load_ushort v112, v29, s[36:39], 0 offen
  s_mov_b32 s70, 0
  buffer_load_dword v224, v30, s[60:63], s70 offen sc1
  s_mov_b32 s70, 12288
  buffer_load_dword v225, v30, s[60:63], s70 offen sc1
  s_mov_b32 s70, 24576
  buffer_load_dword v226, v30, s[60:63], s70 offen sc1
  s_mov_b32 s70, 36864
  buffer_load_dword v227, v30, s[60:63], s70 offen sc1
  s_mul_i32 s70, s68, 458752
  s_lshl_b32 s72, s66, 14
  s_add_u32 s70, s70, s72
  s_add_u32 s70, s70, 9437184
  v_add_u32 v16, s70, v4
  v_lshlrev_b32 v13, 3, v1
  s_mul_i32 s70, s66, 1536
  s_add_u32 s70, s70, 131072
  v_add_u32 v20, s70, v13
  s_mul_i32 s70, s66, 3584
  s_add_u32 s70, s70, 114688
  v_add_u32 v21, s70, v13
  s_add_u32 s70, s66, 1
  s_and_b32 s70, s70, 3
  s_mul_i32 s70, s70, 1536
  s_add_u32 s70, s70, 131072
  v_add_u32 v17, s70, v13
  s_add_u32 s70, s66, 2
  s_and_b32 s70, s70, 3
  s_mul_i32 s70, s70, 1536
  s_add_u32 s70, s70, 131584
  v_add_u32 v18, s70, v13
  s_add_u32 s70, s66, 3
  s_and_b32 s70, s70, 3
  s_mul_i32 s70, s70, 1536
  s_add_u32 s70, s70, 132096
  v_add_u32 v19, s70, v13
  v_lshrrev_b32 v13, 2, v2
  v_cmp_eq_u32 vcc, v13, v3
  v_and_b32 v13, 1, v2
  v_lshlrev_b32 v13, 4, v13
  v_mov_b32 v31, 0x3f80
  v_lshlrev_b32 v31, v13, v31
  v_cndmask_b32 v31, 0, v31, vcc
  v_and_b32 v13, 2, v2
  v_cmp_eq_u32 vcc, 0, v13
  s_nop 1
  v_cndmask_b32 v116, 0, v31, vcc
  v_cndmask_b32 v117, v31, 0, vcc
  v_mov_b32 v118, v116
  v_mov_b32 v119, v117
  v_lshrrev_b32 v13, 1, v3
  v_lshlrev_b32 v13, 8, v13
  v_lshl_add_u32 v13, v2, 4, v13
  v_and_b32 v31, 1, v3
  v_lshl_add_u32 v13, v31, 9, v13
  s_lshl_b32 s70, s67, 2
  s_add_u32 s70, s70, s66
  s_mul_i32 s70, s70, 28672
  s_add_u32 s70, s70, 13631488
  s_lshl_b32 s72, s68, 9
  s_add_u32 s72, s72, s70
  s_add_u32 s72, s72, 24576
  v_add_u32 v27, s72, v13
  s_mul_i32 s72, s68, 3072
  s_add_u32 s70, s70, s72
  v_add_u32 v28, s70, v13
  s_lshl_b32 s70, s68, 2
  s_add_u32 s70, s70, s66
  s_lshl_b32 s70, s70, 8
  s_add_u32 s70, s70, 10240
  v_mov_b32 v13, s70
  s_add_u32 s92, s68, 0
  s_and_b32 s92, s92, 3
  s_lshl_b32 s92, s92, 12
  s_add_u32 s93, s68, 1
  s_and_b32 s93, s93, 3
  s_lshl_b32 s93, s93, 12
  s_add_u32 s94, s68, 2
  s_and_b32 s94, s94, 3
  s_lshl_b32 s94, s94, 12
  s_add_u32 s95, s68, 3
  s_and_b32 s95, s95, 3
  s_lshl_b32 s95, s95, 12
  v_pk_fma_f32 v[32:33], v[64:65], v[128:129], v[32:33] op_sel_hi:[0,1,1]
  v_pk_fma_f32 v[34:35], v[64:65], v[130:131], v[34:35] op_sel_hi:[0,1,1]
  v_pk_fma_f32 v[32:33], v[32:33], v[64:65], v[136:137] op_sel:[0,1,0] op_sel_hi:[1,1,1]
  v_pk_fma_f32 v[34:35], v[34:35], v[64:65], v[138:139] op_sel:[0,1,0] op_sel_hi:[1,1,1]
  v_pk_fma_f32 v[36:37], v[66:67], v[128:129], v[36:37] op_sel_hi:[0,1,1]
  v_pk_fma_f32 v[38:39], v[66:67], v[130:131], v[38:39] op_sel_hi:[0,1,1]
  v_pk_fma_f32 v[36:37], v[36:37], v[66:67], v[136:137] op_sel:[0,1,0] op_sel_hi:[1,1,1]
  v_pk_fma_f32 v[38:39], v[38:39], v[66:67], v[138:139] op_sel:[0,1,0] op_sel_hi:[1,1,1]
  v_pk_fma_f32 v[40:41], v[68:69], v[128:129], v[40:41] op_sel_hi:[0,1,1]
  v_pk_fma_f32 v[42:43], v[68:69], v[130:131], v[42:43] op_sel_hi:[0,1,1]
  v_pk_fma_f32 v[40:41], v[40:41], v[68:69], v[136:137] op_sel:[0,1,0] op_sel_hi:[1,1,1]
  v_pk_fma_f32 v[42:43], v[42:43], v[68:69], v[138:139] op_sel:[0,1,0] op_sel_hi:[1,1,1]
  v_pk_fma_f32 v[44:45], v[70:71], v[128:129], v[44:45] op_sel_hi:[0,1,1]
  v_pk_fma_f32 v[46:47], v[70:71], v[130:131], v[46:47] op_sel_hi:[0,1,1]
  v_pk_fma_f32 v[44:45], v[44:45], v[70:71], v[136:137] op_sel:[0,1,0] op_sel_hi:[1,1,1]
  v_pk_fma_f32 v[46:47], v[46:47], v[70:71], v[138:139] op_sel:[0,1,0] op_sel_hi:[1,1,1]
  v_pk_mul_f32 v[72:73], v[32:33], v[32:33]
  v_pk_mul_f32 v[74:75], v[34:35], v[34:35]
  v_pk_mul_f32 v[76:77], v[36:37], v[36:37]
  v_pk_mul_f32 v[78:79], v[38:39], v[38:39]
  v_pk_fma_f32 v[72:73], v[72:73], v[14:15], v[14:15] op_sel:[0,1,0] op_sel_hi:[1,1,0]
  v_pk_fma_f32 v[74:75], v[74:75], v[14:15], v[14:15] op_sel:[0,1,0] op_sel_hi:[1,1,0]
  v_pk_fma_f32 v[76:77], v[76:77], v[14:15], v[14:15] op_sel:[0,1,0] op_sel_hi:[1,1,0]
  v_pk_fma_f32 v[78:79], v[78:79], v[14:15], v[14:15] op_sel:[0,1,0] op_sel_hi:[1,1,0]
  v_pk_mul_f32 v[72:73], v[72:73], v[32:33]
  v_pk_mul_f32 v[74:75], v[74:75], v[34:35]
  v_pk_mul_f32 v[76:77], v[76:77], v[36:37]
  v_pk_mul_f32 v[78:79], v[78:79], v[38:39]
  v_exp_f32 v72, v72
  v_exp_f32 v73, v73
  v_exp_f32 v74, v74
  v_exp_f32 v75, v75
  v_exp_f32 v76, v76
  v_exp_f32 v77, v77
  v_exp_f32 v78, v78
  v_exp_f32 v79, v79
  v_pk_add_f32 v[72:73], v[72:73], 1.0 op_sel_hi:[1,0]
  v_pk_add_f32 v[74:75], v[74:75], 1.0 op_sel_hi:[1,0]
  v_pk_add_f32 v[76:77], v[76:77], 1.0 op_sel_hi:[1,0]
  v_pk_add_f32 v[78:79], v[78:79], 1.0 op_sel_hi:[1,0]
  v_rcp_f32 v72, v72
  v_rcp_f32 v73, v73
  v_rcp_f32 v74, v74
  v_rcp_f32 v75, v75
  v_rcp_f32 v76, v76
  v_rcp_f32 v77, v77
  v_rcp_f32 v78, v78
  v_rcp_f32 v79, v79
  v_pk_mul_f32 v[72:73], v[72:73], v[32:33]
  v_pk_mul_f32 v[74:75], v[74:75], v[34:35]
  v_pk_mul_f32 v[76:77], v[76:77], v[36:37]
  v_pk_mul_f32 v[78:79], v[78:79], v[38:39]
  v_cvt_pk_bf16_f32 v96, v72, v73
  v_cvt_pk_bf16_f32 v97, v74, v75
  v_cvt_pk_bf16_f32 v98, v76, v77
  v_cvt_pk_bf16_f32 v99, v78, v79
  v_pk_mul_f32 v[72:73], v[40:41], v[40:41]
  v_pk_mul_f32 v[74:75], v[42:43], v[42:43]
  v_pk_mul_f32 v[76:77], v[44:45], v[44:45]
  v_pk_mul_f32 v[78:79], v[46:47], v[46:47]
  v_pk_fma_f32 v[72:73], v[72:73], v[14:15], v[14:15] op_sel:[0,1,0] op_sel_hi:[1,1,0]
  v_pk_fma_f32 v[74:75], v[74:75], v[14:15], v[14:15] op_sel:[0,1,0] op_sel_hi:[1,1,0]
  v_pk_fma_f32 v[76:77], v[76:77], v[14:15], v[14:15] op_sel:[0,1,0] op_sel_hi:[1,1,0]
  v_pk_fma_f32 v[78:79], v[78:79], v[14:15], v[14:15] op_sel:[0,1,0] op_sel_hi:[1,1,0]
  v_pk_mul_f32 v[72:73], v[72:73], v[40:41]
  v_pk_mul_f32 v[74:75], v[74:75], v[42:43]
  v_pk_mul_f32 v[76:77], v[76:77], v[44:45]
  v_pk_mul_f32 v[78:79], v[78:79], v[46:47]
  v_exp_f32 v72, v72
  v_exp_f32 v73, v73
  v_exp_f32 v74, v74
  v_exp_f32 v75, v75
  v_exp_f32 v76, v76
  v_exp_f32 v77, v77
  v_exp_f32 v78, v78
  v_exp_f32 v79, v79
  v_pk_add_f32 v[72:73], v[72:73], 1.0 op_sel_hi:[1,0]
  v_pk_add_f32 v[74:75], v[74:75], 1.0 op_sel_hi:[1,0]
  v_pk_add_f32 v[76:77], v[76:77], 1.0 op_sel_hi:[1,0]
  v_pk_add_f32 v[78:79], v[78:79], 1.0 op_sel_hi:[1,0]
  v_rcp_f32 v72, v72
  v_rcp_f32 v73, v73
  v_rcp_f32 v74, v74
  v_rcp_f32 v75, v75
  v_rcp_f32 v76, v76
  v_rcp_f32 v77, v77
  v_rcp_f32 v78, v78
  v_rcp_f32 v79, v79
  v_pk_mul_f32 v[72:73], v[72:73], v[40:41]
  v_pk_mul_f32 v[74:75], v[74:75], v[42:43]
  v_pk_mul_f32 v[76:77], v[76:77], v[44:45]
  v_pk_mul_f32 v[78:79], v[78:79], v[46:47]
  v_cvt_pk_bf16_f32 v100, v72, v73
  v_cvt_pk_bf16_f32 v101, v74, v75
  v_cvt_pk_bf16_f32 v102, v76, v77
  v_cvt_pk_bf16_f32 v103, v78, v79
  ds_write_b64 v89, v[96:97]
  ds_write_b64 v90, v[98:99]
  ds_write_b64 v91, v[100:101]
  ds_write_b64 v92, v[102:103]
  s_mov_b32 s77, 0
  s_mov_b64 exec, 0x1
L_poll_27:
  buffer_load_dword v31, v13, s[60:63], 0 offen  sc1
  s_waitcnt vmcnt(0)
  v_cmp_gt_u32 vcc, 8, v31
  s_nop 0
  s_cbranch_vccz L_polld_28
  s_sleep 1
  s_add_u32 s77, s77, 1
  s_cmp_lt_u32 s77, 200000
  s_cbranch_scc1 L_poll_27
L_polld_28:
  s_mov_b64 exec, -1
  buffer_load_dwordx4 v[160:163], v16, s[60:63], s92 offen offset:0 sc1
  buffer_load_dwordx4 v[164:167], v16, s[60:63], s92 offen offset:1024 sc1
  buffer_load_dwordx4 v[168:171], v16, s[60:63], s92 offen offset:2048 sc1
  buffer_load_dwordx4 v[172:175], v16, s[60:63], s92 offen offset:3072 sc1
  buffer_load_dwordx4 v[176:179], v16, s[60:63], s93 offen offset:0 sc1
  buffer_load_dwordx4 v[180:183], v16, s[60:63], s93 offen offset:1024 sc1
  buffer_load_dwordx4 v[184:187], v16, s[60:63], s93 offen offset:2048 sc1
  buffer_load_dwordx4 v[188:191], v16, s[60:63], s93 offen offset:3072 sc1
  buffer_load_dwordx4 v[192:195], v16, s[60:63], s94 offen offset:0 sc1
  buffer_load_dwordx4 v[196:199], v16, s[60:63], s94 offen offset:1024 sc1
  buffer_load_dwordx4 v[200:203], v16, s[60:63], s94 offen offset:2048 sc1
  buffer_load_dwordx4 v[204:207], v16, s[60:63], s94 offen offset:3072 sc1
  buffer_load_dwordx4 v[208:211], v16, s[60:63], s95 offen offset:0 sc1
  buffer_load_dwordx4 v[212:215], v16, s[60:63], s95 offen offset:1024 sc1
  buffer_load_dwordx4 v[216:219], v16, s[60:63], s95 offen offset:2048 sc1
  buffer_load_dwordx4 v[220:223], v16, s[60:63], s95 offen offset:3072 sc1
  v_add_u32 v16, 0x10000, v16
  s_cmp_lg_u32 s66, 3
  s_cbranch_scc0 L_ow_30
  v_pk_fma_f32 v[48:49], v[64:65], v[132:133], v[48:49] op_sel_hi:[0,1,1]
  v_pk_fma_f32 v[50:51], v[64:65], v[134:135], v[50:51] op_sel_hi:[0,1,1]
  v_pk_fma_f32 v[48:49], v[48:49], v[64:65], v[140:141] op_sel:[0,1,0] op_sel_hi:[1,1,1]
  v_pk_fma_f32 v[50:51], v[50:51], v[64:65], v[142:143] op_sel:[0,1,0] op_sel_hi:[1,1,1]
  v_pk_fma_f32 v[52:53], v[66:67], v[132:133], v[52:53] op_sel_hi:[0,1,1]
  v_pk_fma_f32 v[54:55], v[66:67], v[134:135], v[54:55] op_sel_hi:[0,1,1]
  v_pk_fma_f32 v[52:53], v[52:53], v[66:67], v[140:141] op_sel:[0,1,0] op_sel_hi:[1,1,1]
  v_pk_fma_f32 v[54:55], v[54:55], v[66:67], v[142:143] op_sel:[0,1,0] op_sel_hi:[1,1,1]
  v_pk_fma_f32 v[56:57], v[68:69], v[132:133], v[56:57] op_sel_hi:[0,1,1]
  v_pk_fma_f32 v[58:59], v[68:69], v[134:135], v[58:59] op_sel_hi:[0,1,1]
  v_pk_fma_f32 v[56:57], v[56:57], v[68:69], v[140:141] op_sel:[0,1,0] op_sel_hi:[1,1,1]
  v_pk_fma_f32 v[58:59], v[58:59], v[68:69], v[142:143] op_sel:[0,1,0] op_sel_hi:[1,1,1]
  v_pk_fma_f32 v[60:61], v[70:71], v[132:133], v[60:61] op_sel_hi:[0,1,1]
  v_pk_fma_f32 v[62:63], v[70:71], v[134:135], v[62:63] op_sel_hi:[0,1,1]
  v_pk_fma_f32 v[60:61], v[60:61], v[70:71], v[140:141] op_sel:[0,1,0] op_sel_hi:[1,1,1]
  v_pk_fma_f32 v[62:63], v[62:63], v[70:71], v[142:143] op_sel:[0,1,0] op_sel_hi:[1,1,1]
  v_pk_mul_f32 v[72:73], v[48:49], v[48:49]
  v_pk_mul_f32 v[74:75], v[50:51], v[50:51]
  v_pk_mul_f32 v[76:77], v[52:53], v[52:53]
  v_pk_mul_f32 v[78:79], v[54:55], v[54:55]
  v_pk_fma_f32 v[72:73], v[72:73], v[14:15], v[14:15] op_sel:[0,1,0] op_sel_hi:[1,1,0]
  v_pk_fma_f32 v[74:75], v[74:75], v[14:15], v[14:15] op_sel:[0,1,0] op_sel_hi:[1,1,0]
  v_pk_fma_f32 v[76:77], v[76:77], v[14:15], v[14:15] op_sel:[0,1,0] op_sel_hi:[1,1,0]
  v_pk_fma_f32 v[78:79], v[78:79], v[14:15], v[14:15] op_sel:[0,1,0] op_sel_hi:[1,1,0]
  v_pk_mul_f32 v[72:73], v[72:73], v[48:49]
  v_pk_mul_f32 v[74:75], v[74:75], v[50:51]
  v_pk_mul_f32 v[76:77], v[76:77], v[52:53]
  v_pk_mul_f32 v[78:79], v[78:79], v[54:55]
  v_exp_f32 v72, v72
  v_exp_f32 v73, v73
  v_exp_f32 v74, v74
  v_exp_f32 v75, v75
  v_exp_f32 v76, v76
  v_exp_f32 v77, v77
  v_exp_f32 v78, v78
  v_exp_f32 v79, v79
  v_pk_add_f32 v[72:73], v[72:73], 1.0 op_sel_hi:[1,0]
  v_pk_add_f32 v[74:75], v[74:75], 1.0 op_sel_hi:[1,0]
  v_pk_add_f32 v[76:77], v[76:77], 1.0 op_sel_hi:[1,0]
  v_pk_add_f32 v[78:79], v[78:79], 1.0 op_sel_hi:[1,0]
  v_rcp_f32 v72, v72
  v_rcp_f32 v73, v73
  v_rcp_f32 v74, v74
  v_rcp_f32 v75, v75
  v_rcp_f32 v76, v76
  v_rcp_f32 v77, v77
  v_rcp_f32 v78, v78
  v_rcp_f32 v79, v79
  v_pk_mul_f32 v[72:73], v[72:73], v[48:49]
  v_pk_mul_f32 v[74:75], v[74:75], v[50:51]
  v_pk_mul_f32 v[76:77], v[76:77], v[52:53]
  v_pk_mul_f32 v[78:79], v[78:79], v[54:55]
  v_cvt_pk_bf16_f32 v104, v72, v73
  v_cvt_pk_bf16_f32 v105, v74, v75
  v_cvt_pk_bf16_f32 v106, v76, v77
  v_cvt_pk_bf16_f32 v107, v78, v79
  v_pk_mul_f32 v[72:73], v[56:57], v[56:57]
  v_pk_mul_f32 v[74:75], v[58:59], v[58:59]
  v_pk_mul_f32 v[76:77], v[60:61], v[60:61]
  v_pk_mul_f32 v[78:79], v[62:63], v[62:63]
  v_pk_fma_f32 v[72:73], v[72:73], v[14:15], v[14:15] op_sel:[0,1,0] op_sel_hi:[1,1,0]
  v_pk_fma_f32 v[74:75], v[74:75], v[14:15], v[14:15] op_sel:[0,1,0] op_sel_hi:[1,1,0]
  v_pk_fma_f32 v[76:77], v[76:77], v[14:15], v[14:15] op_sel:[0,1,0] op_sel_hi:[1,1,0]
  v_pk_fma_f32 v[78:79], v[78:79], v[14:15], v[14:15] op_sel:[0,1,0] op_sel_hi:[1,1,0]
  v_pk_mul_f32 v[72:73], v[72:73], v[56:57]
  v_pk_mul_f32 v[74:75], v[74:75], v[58:59]
  v_pk_mul_f32 v[76:77], v[76:77], v[60:61]
  v_pk_mul_f32 v[78:79], v[78:79], v[62:63]
  v_exp_f32 v72, v72
  v_exp_f32 v73, v73
  v_exp_f32 v74, v74
  v_exp_f32 v75, v75
  v_exp_f32 v76, v76
  v_exp_f32 v77, v77
  v_exp_f32 v78, v78
  v_exp_f32 v79, v79
  v_pk_add_f32 v[72:73], v[72:73], 1.0 op_sel_hi:[1,0]
  v_pk_add_f32 v[74:75], v[74:75], 1.0 op_sel_hi:[1,0]
  v_pk_add_f32 v[76:77], v[76:77], 1.0 op_sel_hi:[1,0]
  v_pk_add_f32 v[78:79], v[78:79], 1.0 op_sel_hi:[1,0]
  v_rcp_f32 v72, v72
  v_rcp_f32 v73, v73
  v_rcp_f32 v74, v74
  v_rcp_f32 v75, v75
  v_rcp_f32 v76, v76
  v_rcp_f32 v77, v77
  v_rcp_f32 v78, v78
  v_rcp_f32 v79, v79
  v_pk_mul_f32 v[72:73], v[72:73], v[56:57]
  v_pk_mul_f32 v[74:75], v[74:75], v[58:59]
  v_pk_mul_f32 v[76:77], v[76:77], v[60:61]
  v_pk_mul_f32 v[78:79], v[78:79], v[62:63]
  v_cvt_pk_bf16_f32 v108, v72, v73
  v_cvt_pk_bf16_f32 v109, v74, v75
  v_cvt_pk_bf16_f32 v110, v76, v77
  v_cvt_pk_bf16_f32 v111, v78, v79
  ds_write_b64 v89, v[104:105] offset:512
  ds_write_b64 v90, v[106:107] offset:512
  ds_write_b64 v91, v[108:109] offset:512
  ds_write_b64 v92, v[110:111] offset:512
L_ow_30:
  v_lshlrev_b32 v112, 16, v112
  v_add_f32 v224, v224, v225
  v_add_f32 v226, v226, v227
  v_mov_b32 v113, v112
  v_add_f32 v224, v224, v226
  v_mov_b32 v114, v112
  v_cvt_pk_bf16_f32 v224, v224, v224
  v_mov_b32 v115, v112
  v_and_b32 v224, s69, v224
  s_lshl_b32 s70, s66, 8
  s_add_u32 s70, s70, 148480
  v_lshl_add_u32 v13, v1, 2, s70
  v_lshl_add_u32 v31, v3, 4, s70
  ds_write_b32 v13, v224
  s_waitcnt lgkmcnt(0)
  ds_read_b128 v[224:227], v31 offset:0
  ds_read_b128 v[228:231], v31 offset:64
  ds_read_b128 v[232:235], v31 offset:128
  ds_read_b128 v[236:239], v31 offset:192
  s_lshl_b32 s91, s67, 8
  s_add_u32 s91, s91, 18432
  v_mov_b32 v22, s91
  v_mov_b32 v23, 1
  s_waitcnt vmcnt(15)
  s_waitcnt lgkmcnt(0)
  v_mfma_f32_16x16x32_bf16 v[32:35], v[160:163], a[0:3], v[112:115]
  v_mfma_f32_16x16x32_bf16 v[36:39], v[160:163], a[4:7], 0
  v_mfma_f32_16x16x32_bf16 v[40:43], v[160:163], a[8:11], 0
  v_mfma_f32_16x16x32_bf16 v[44:47], v[160:163], a[12:15], 0
  s_waitcnt vmcnt(14)
  v_mfma_f32_16x16x32_bf16 v[32:35], v[164:167], a[16:19], v[32:35]
  buffer_load_dwordx4 v[160:163], v16, s[60:63], s92 offen offset:0 sc1
  v_mfma_f32_16x16x32_bf16 v[36:39], v[164:167], a[20:23], v[36:39]
  v_mfma_f32_16x16x32_bf16 v[40:43], v[164:167], a[24:27], v[40:43]
  v_mfma_f32_16x16x32_bf16 v[44:47], v[164:167], a[28:31], v[44:47]
  s_waitcnt vmcnt(14)
  v_mfma_f32_16x16x32_bf16 v[32:35], v[168:171], a[32:35], v[32:35]
  buffer_load_dwordx4 v[164:167], v16, s[60:63], s92 offen offset:1024 sc1
  v_mfma_f32_16x16x32_bf16 v[36:39], v[168:171], a[36:39], v[36:39]
  v_mfma_f32_16x16x32_bf16 v[40:43], v[168:171], a[40:43], v[40:43]
  v_mfma_f32_16x16x32_bf16 v[44:47], v[168:171], a[44:47], v[44:47]
  s_waitcnt vmcnt(14)
  v_mfma_f32_16x16x32_bf16 v[32:35], v[172:175], a[48:51], v[32:35]
  buffer_load_dwordx4 v[168:171], v16, s[60:63], s92 offen offset:2048 sc1
  v_mfma_f32_16x16x32_bf16 v[36:39], v[172:175], a[52:55], v[36:39]
  v_mfma_f32_16x16x32_bf16 v[40:43], v[172:175], a[56:59], v[40:43]
  v_mfma_f32_16x16x32_bf16 v[44:47], v[172:175], a[60:63], v[44:47]
  s_waitcnt vmcnt(14)
  v_mfma_f32_16x16x32_bf16 v[32:35], v[176:179], a[64:67], v[32:35]
  buffer_load_dwordx4 v[172:175], v16, s[60:63], s92 offen offset:3072 sc1
  v_mfma_f32_16x16x32_bf16 v[36:39], v[176:179], a[68:71], v[36:39]
  s_waitcnt lgkmcnt(0)
  s_barrier
  v_mfma_f32_16x16x32_bf16 v[40:43], v[176:179], a[72:75], v[40:43]
  v_mfma_f32_16x16x32_bf16 v[44:47], v[176:179], a[76:79], v[44:47]
  s_waitcnt vmcnt(14)
  v_mfma_f32_16x16x32_bf16 v[32:35], v[180:183], a[80:83], v[32:35]
  buffer_load_dwordx4 v[176:179], v16, s[60:63], s93 offen offset:0 sc1
  v_mfma_f32_16x16x32_bf16 v[36:39], v[180:183], a[84:87], v[36:39]
  v_mfma_f32_16x16x32_bf16 v[40:43], v[180:183], a[88:91], v[40:43]
  v_mfma_f32_16x16x32_bf16 v[44:47], v[180:183], a[92:95], v[44:47]
  s_waitcnt vmcnt(14)
  v_mfma_f32_16x16x32_bf16 v[32:35], v[184:187], a[96:99], v[32:35]
  buffer_load_dwordx4 v[180:183], v16, s[60:63], s93 offen offset:1024 sc1
  v_mfma_f32_16x16x32_bf16 v[36:39], v[184:187], a[100:103], v[36:39]
  v_mfma_f32_16x16x32_bf16 v[40:43], v[184:187], a[104:107], v[40:43]
  v_mfma_f32_16x16x32_bf16 v[44:47], v[184:187], a[108:111], v[44:47]
  s_waitcnt vmcnt(14)
  v_mfma_f32_16x16x32_bf16 v[32:35], v[188:191], a[112:115], v[32:35]
  buffer_load_dwordx4 v[184:187], v16, s[60:63], s93 offen offset:2048 sc1
  v_mfma_f32_16x16x32_bf16 v[36:39], v[188:191], a[116:119], v[36:39]
  v_mfma_f32_16x16x32_bf16 v[40:43], v[188:191], a[120:123], v[40:43]
  v_mfma_f32_16x16x32_bf16 v[44:47], v[188:191], a[124:127], v[44:47]
  s_waitcnt vmcnt(14)
  v_mfma_f32_16x16x32_bf16 v[32:35], v[192:195], a[128:131], v[32:35]
  buffer_load_dwordx4 v[188:191], v16, s[60:63], s93 offen offset:3072 sc1
  v_mfma_f32_16x16x32_bf16 v[36:39], v[192:195], a[132:135], v[36:39]
  v_mfma_f32_16x16x32_bf16 v[40:43], v[192:195], a[136:139], v[40:43]
  v_mfma_f32_16x16x32_bf16 v[44:47], v[192:195], a[140:143], v[44:47]
  s_waitcnt vmcnt(14)
  v_mfma_f32_16x16x32_bf16 v[32:35], v[196:199], a[144:147], v[32:35]
  buffer_load_dwordx4 v[192:195], v16, s[60:63], s94 offen offset:0 sc1
  v_mfma_f32_16x16x32_bf16 v[36:39], v[196:199], a[148:151], v[36:39]
  v_mfma_f32_16x16x32_bf16 v[40:43], v[196:199], a[152:155], v[40:43]
  v_mfma_f32_16x16x32_bf16 v[44:47], v[196:199], a[156:159], v[44:47]
  s_waitcnt vmcnt(14)
  v_mfma_f32_16x16x32_bf16 v[32:35], v[200:203], a[160:163], v[32:35]
  buffer_load_dwordx4 v[196:199], v16, s[60:63], s94 offen offset:1024 sc1
  v_mfma_f32_16x16x32_bf16 v[36:39], v[200:203], a[164:167], v[36:39]
  v_mfma_f32_16x16x32_bf16 v[40:43], v[200:203], a[168:171], v[40:43]
  v_mfma_f32_16x16x32_bf16 v[44:47], v[200:203], a[172:175], v[44:47]
  s_waitcnt vmcnt(14)
  v_mfma_f32_16x16x32_bf16 v[32:35], v[204:207], a[176:179], v[32:35]
  buffer_load_dwordx4 v[200:203], v16, s[60:63], s94 offen offset:2048 sc1
  v_mfma_f32_16x16x32_bf16 v[36:39], v[204:207], a[180:183], v[36:39]
  v_mfma_f32_16x16x32_bf16 v[40:43], v[204:207], a[184:187], v[40:43]
  v_mfma_f32_16x16x32_bf16 v[44:47], v[204:207], a[188:191], v[44:47]
  s_waitcnt vmcnt(14)
  v_mfma_f32_16x16x32_bf16 v[32:35], v[208:211], a[192:195], v[32:35]
  buffer_load_dwordx4 v[204:207], v16, s[60:63], s94 offen offset:3072 sc1
  v_mfma_f32_16x16x32_bf16 v[36:39], v[208:211], a[196:199], v[36:39]
  v_mfma_f32_16x16x32_bf16 v[40:43], v[208:211], a[200:203], v[40:43]
  v_mfma_f32_16x16x32_bf16 v[44:47], v[208:211], a[204:207], v[44:47]
  s_waitcnt vmcnt(14)
  v_mfma_f32_16x16x32_bf16 v[32:35], v[212:215], a[208:211], v[32:35]
  buffer_load_dwordx4 v[208:211], v16, s[60:63], s95 offen offset:0 sc1
  v_mfma_f32_16x16x32_bf16 v[36:39], v[212:215], a[212:215], v[36:39]
  v_mfma_f32_16x16x32_bf16 v[40:43], v[212:215], a[216:219], v[40:43]
  v_mfma_f32_16x16x32_bf16 v[44:47], v[212:215], a[220:223], v[44:47]
  s_waitcnt vmcnt(14)
  v_mfma_f32_16x16x32_bf16 v[32:35], v[216:219], a[224:227], v[32:35]
  buffer_load_dwordx4 v[212:215], v16, s[60:63], s95 offen offset:1024 sc1
  v_mfma_f32_16x16x32_bf16 v[36:39], v[216:219], a[228:231], v[36:39]
  v_mfma_f32_16x16x32_bf16 v[40:43], v[216:219], a[232:235], v[40:43]
  v_mfma_f32_16x16x32_bf16 v[44:47], v[216:219], a[236:239], v[44:47]
  s_waitcnt vmcnt(14)
  v_mfma_f32_16x16x32_bf16 v[32:35], v[220:223], a[240:243], v[32:35]
  buffer_load_dwordx4 v[216:219], v16, s[60:63], s95 offen offset:2048 sc1
  v_mfma_f32_16x16x32_bf16 v[36:39], v[220:223], a[244:247], v[36:39]
  v_mfma_f32_16x16x32_bf16 v[40:43], v[220:223], a[248:251], v[40:43]
  v_mfma_f32_16x16x32_bf16 v[44:47], v[220:223], a[252:255], v[44:47]
  s_waitcnt vmcnt(14)
  v_mfma_f32_16x16x32_bf16 v[48:51], v[160:163], a[0:3], v[112:115]
  buffer_load_dwordx4 v[220:223], v16, s[60:63], s95 offen offset:3072 sc1
  v_add_u32 v16, 0x10000, v16
  v_mfma_f32_16x16x32_bf16 v[52:55], v[160:163], a[4:7], 0
  v_mfma_f32_16x16x32_bf16 v[56:59], v[160:163], a[8:11], 0
  v_mfma_f32_16x16x32_bf16 v[60:63], v[160:163], a[12:15], 0
  s_waitcnt vmcnt(14)
  v_mfma_f32_16x16x32_bf16 v[48:51], v[164:167], a[16:19], v[48:51]
  buffer_load_dwordx4 v[160:163], v16, s[60:63], s92 offen offset:0 sc1
  v_mfma_f32_16x16x32_bf16 v[52:55], v[164:167], a[20:23], v[52:55]
  v_cvt_pk_bf16_f32 v64, v36, v37
  v_cvt_pk_bf16_f32 v65, v38, v39
  v_mfma_f32_16x16x32_bf16 v[56:59], v[164:167], a[24:27], v[56:59]
  v_cvt_pk_bf16_f32 v66, v40, v41
  v_cvt_pk_bf16_f32 v67, v42, v43
  v_mfma_f32_16x16x32_bf16 v[60:63], v[164:167], a[28:31], v[60:63]
  s_waitcnt vmcnt(14)
  v_mfma_f32_16x16x32_bf16 v[48:51], v[168:171], a[32:35], v[48:51]
  buffer_load_dwordx4 v[164:167], v16, s[60:63], s92 offen offset:1024 sc1
  v_mfma_f32_16x16x32_bf16 v[52:55], v[168:171], a[36:39], v[52:55]
  v_cvt_pk_bf16_f32 v68, v44, v45
  v_cvt_pk_bf16_f32 v69, v46, v47
  v_mfma_f32_16x16x32_bf16 v[56:59], v[168:171], a[40:43], v[56:59]
  ds_write_b64 v17, v[64:65] offset:0
  v_mfma_f32_16x16x32_bf16 v[60:63], v[168:171], a[44:47], v[60:63]
  ds_write_b64 v18, v[66:67] offset:0
  s_waitcnt vmcnt(14)
  v_mfma_f32_16x16x32_bf16 v[48:51], v[172:175], a[48:51], v[48:51]
  buffer_load_dwordx4 v[168:171], v16, s[60:63], s92 offen offset:2048 sc1
  v_mfma_f32_16x16x32_bf16 v[52:55], v[172:175], a[52:55], v[52:55]
  ds_write_b64 v19, v[68:69] offset:0
  v_mfma_f32_16x16x32_bf16 v[56:59], v[172:175], a[56:59], v[56:59]
  ds_read_b64 v[78:79], v21 offset:0
  v_mfma_f32_16x16x32_bf16 v[60:63], v[172:175], a[60:63], v[60:63]
  s_waitcnt vmcnt(14)
  v_mfma_f32_16x16x32_bf16 v[48:51], v[176:179], a[64:67], v[48:51]
  buffer_load_dwordx4 v[172:175], v16, s[60:63], s92 offen offset:3072 sc1
  v_mfma_f32_16x16x32_bf16 v[52:55], v[176:179], a[68:71], v[52:55]
  v_mfma_f32_16x16x32_bf16 v[56:59], v[176:179], a[72:75], v[56:59]
  v_mfma_f32_16x16x32_bf16 v[60:63], v[176:179], a[76:79], v[60:63]
  s_waitcnt lgkmcnt(0)
  s_barrier
  s_waitcnt vmcnt(14)
  v_mfma_f32_16x16x32_bf16 v[48:51], v[180:183], a[80:83], v[48:51]
  buffer_load_dwordx4 v[176:179], v16, s[60:63], s93 offen offset:0 sc1
  v_mfma_f32_16x16x32_bf16 v[52:55], v[180:183], a[84:87], v[52:55]
  ds_read_b64 v[72:73], v20 offset:0
  v_mfma_f32_16x16x32_bf16 v[56:59], v[180:183], a[88:91], v[56:59]
  ds_read_b64 v[74:75], v20 offset:512
  v_mfma_f32_16x16x32_bf16 v[60:63], v[180:183], a[92:95], v[60:63]
  ds_read_b64 v[76:77], v20 offset:1024
  s_waitcnt vmcnt(14)
  v_mfma_f32_16x16x32_bf16 v[48:51], v[184:187], a[96:99], v[48:51]
  buffer_load_dwordx4 v[180:183], v16, s[60:63], s93 offen offset:1024 sc1
  v_mfma_f32_16x16x32_bf16 v[52:55], v[184:187], a[100:103], v[52:55]
  v_lshlrev_b32 v80, 16, v78
  v_and_b32 v81, s69, v78
  v_mfma_f32_16x16x32_bf16 v[56:59], v[184:187], a[104:107], v[56:59]
  v_lshlrev_b32 v82, 16, v79
  v_and_b32 v83, s69, v79
  v_mfma_f32_16x16x32_bf16 v[60:63], v[184:187], a[108:111], v[60:63]
  s_waitcnt vmcnt(14)
  v_mfma_f32_16x16x32_bf16 v[48:51], v[188:191], a[112:115], v[48:51]
  buffer_load_dwordx4 v[184:187], v16, s[60:63], s93 offen offset:2048 sc1
  v_mfma_f32_16x16x32_bf16 v[52:55], v[188:191], a[116:119], v[52:55]
  v_mfma_f32_16x16x32_bf16 v[56:59], v[188:191], a[120:123], v[56:59]
  s_waitcnt lgkmcnt(0)
  v_mfma_f32_16x16x32_bf16 v[32:35], v[116:119], v[72:75], v[32:35]
  v_mfma_f32_16x16x32_bf16 v[60:63], v[188:191], a[124:127], v[60:63]
  s_waitcnt vmcnt(14)
  v_mfma_f32_16x16x32_bf16 v[48:51], v[192:195], a[128:131], v[48:51]
  buffer_load_dwordx4 v[188:191], v16, s[60:63], s93 offen offset:3072 sc1
  v_mfma_f32_16x16x32_bf16 v[52:55], v[192:195], a[132:135], v[52:55]
  v_mfma_f32_16x16x32_bf16 v[56:59], v[192:195], a[136:139], v[56:59]
  v_mfma_f32_16x16x32_bf16 v[60:63], v[192:195], a[140:143], v[60:63]
  s_waitcnt vmcnt(14)
  v_mfma_f32_16x16x32_bf16 v[48:51], v[196:199], a[144:147], v[48:51]
  buffer_load_dwordx4 v[192:195], v16, s[60:63], s94 offen offset:0 sc1
  v_mfma_f32_16x16x32_bf16 v[52:55], v[196:199], a[148:151], v[52:55]
  v_mfma_f32_16x16x16_bf16 v[32:35], v[116:117], v[76:77], v[32:35]
  v_mfma_f32_16x16x32_bf16 v[56:59], v[196:199], a[152:155], v[56:59]
  v_mfma_f32_16x16x32_bf16 v[60:63], v[196:199], a[156:159], v[60:63]
  s_waitcnt vmcnt(14)
  v_mfma_f32_16x16x32_bf16 v[48:51], v[200:203], a[160:163], v[48:51]
  buffer_load_dwordx4 v[196:199], v16, s[60:63], s94 offen offset:1024 sc1
  v_mfma_f32_16x16x32_bf16 v[52:55], v[200:203], a[164:167], v[52:55]
  v_mfma_f32_16x16x32_bf16 v[56:59], v[200:203], a[168:171], v[56:59]
  v_mfma_f32_16x16x32_bf16 v[60:63], v[200:203], a[172:175], v[60:63]
  s_waitcnt vmcnt(14)
  v_mfma_f32_16x16x32_bf16 v[48:51], v[204:207], a[176:179], v[48:51]
  buffer_load_dwordx4 v[200:203], v16, s[60:63], s94 offen offset:2048 sc1
  v_mfma_f32_16x16x32_bf16 v[52:55], v[204:207], a[180:183], v[52:55]
  v_mul_f32 v80, v80, v32
  v_mul_f32 v81, v81, v33
  v_mfma_f32_16x16x32_bf16 v[56:59], v[204:207], a[184:187], v[56:59]
  v_mul_f32 v82, v82, v34
  v_mul_f32 v83, v83, v35
  v_mfma_f32_16x16x32_bf16 v[60:63], v[204:207], a[188:191], v[60:63]
  s_waitcnt vmcnt(14)
  v_mfma_f32_16x16x32_bf16 v[48:51], v[208:211], a[192:195], v[48:51]
  buffer_load_dwordx4 v[204:207], v16, s[60:63], s94 offen offset:3072 sc1
  v_mfma_f32_16x16x32_bf16 v[52:55], v[208:211], a[196:199], v[52:55]
  v_cvt_pk_bf16_f32 v84, v80, v81
  v_cvt_pk_bf16_f32 v85, v82, v83
  v_mfma_f32_16x16x32_bf16 v[56:59], v[208:211], a[200:203], v[56:59]
  v_mfma_f32_16x16x32_bf16 v[60:63], v[208:211], a[204:207], v[60:63]
  s_waitcnt vmcnt(14)
  v_mfma_f32_16x16x32_bf16 v[48:51], v[212:215], a[208:211], v[48:51]
  buffer_load_dwordx4 v[208:211], v16, s[60:63], s95 offen offset:0 sc1
  v_mfma_f32_16x16x32_bf16 v[52:55], v[212:215], a[212:215], v[52:55]
  v_mfma_f32_16x16x32_bf16 v[56:59], v[212:215], a[216:219], v[56:59]
  v_mfma_f32_16x16x32_bf16 v[60:63], v[212:215], a[220:223], v[60:63]
  s_waitcnt vmcnt(14)
  v_mfma_f32_16x16x32_bf16 v[48:51], v[216:219], a[224:227], v[48:51]
  buffer_load_dwordx4 v[212:215], v16, s[60:63], s95 offen offset:1024 sc1
  v_mfma_f32_16x16x32_bf16 v[52:55], v[216:219], a[228:231], v[52:55]
  v_mfma_f32_16x16x32_bf16 v[56:59], v[216:219], a[232:235], v[56:59]
  v_mfma_f32_16x16x32_bf16 v[60:63], v[216:219], a[236:239], v[60:63]
  s_waitcnt vmcnt(14)
  v_mfma_f32_16x16x32_bf16 v[48:51], v[220:223], a[240:243], v[48:51]
  buffer_load_dwordx4 v[216:219], v16, s[60:63], s95 offen offset:2048 sc1
  v_mfma_f32_16x16x32_bf16 v[52:55], v[220:223], a[244:247], v[52:55]
  v_mfma_f32_16x16x32_bf16 v[56:59], v[220:223], a[248:251], v[56:59]
  v_mfma_f32_16x16x32_bf16 v[60:63], v[220:223], a[252:255], v[60:63]
  s_waitcnt vmcnt(14)
  v_mfma_f32_16x16x32_bf16 v[32:35], v[160:163], a[0:3], v[112:115]
  buffer_load_dwordx4 v[220:223], v16, s[60:63], s95 offen offset:3072 sc1
  v_add_u32 v16, 0x10000, v16
  v_mfma_f32_16x16x32_bf16 v[36:39], v[160:163], a[4:7], 0
  v_mfma_f32_16x16x32_bf16 v[40:43], v[160:163], a[8:11], 0
  v_mfma_f32_16x16x32_bf16 v[44:47], v[160:163], a[12:15], 0
  s_waitcnt vmcnt(14)
  v_mfma_f32_16x16x32_bf16 v[32:35], v[164:167], a[16:19], v[32:35]
  buffer_load_dwordx4 v[160:163], v16, s[60:63], s92 offen offset:0 sc1
  v_mfma_f32_16x16x32_bf16 v[36:39], v[164:167], a[20:23], v[36:39]
  v_cvt_pk_bf16_f32 v64, v52, v53
  v_cvt_pk_bf16_f32 v65, v54, v55
  v_mfma_f32_16x16x32_bf16 v[40:43], v[164:167], a[24:27], v[40:43]
  v_cvt_pk_bf16_f32 v66, v56, v57
  v_cvt_pk_bf16_f32 v67, v58, v59
  v_mfma_f32_16x16x32_bf16 v[44:47], v[164:167], a[28:31], v[44:47]
  s_waitcnt vmcnt(14)
  v_mfma_f32_16x16x32_bf16 v[32:35], v[168:171], a[32:35], v[32:35]
  buffer_load_dwordx4 v[164:167], v16, s[60:63], s92 offen offset:1024 sc1
  v_mfma_f32_16x16x32_bf16 v[36:39], v[168:171], a[36:39], v[36:39]
  v_cvt_pk_bf16_f32 v68, v60, v61
  v_cvt_pk_bf16_f32 v69, v62, v63
  v_mfma_f32_16x16x32_bf16 v[40:43], v[168:171], a[40:43], v[40:43]
  ds_write_b64 v17, v[64:65] offset:8192
  v_mfma_f32_16x16x32_bf16 v[44:47], v[168:171], a[44:47], v[44:47]
  ds_write_b64 v18, v[66:67] offset:8192
  s_waitcnt vmcnt(14)
  v_mfma_f32_16x16x32_bf16 v[32:35], v[172:175], a[48:51], v[32:35]
  buffer_load_dwordx4 v[168:171], v16, s[60:63], s92 offen offset:2048 sc1
  v_mfma_f32_16x16x32_bf16 v[36:39], v[172:175], a[52:55], v[36:39]
  ds_write_b64 v19, v[68:69] offset:8192
  v_mfma_f32_16x16x32_bf16 v[40:43], v[172:175], a[56:59], v[40:43]
  ds_read_b64 v[78:79], v21 offset:512
  v_mfma_f32_16x16x32_bf16 v[44:47], v[172:175], a[60:63], v[44:47]
  s_waitcnt vmcnt(14)
  v_mfma_f32_16x16x32_bf16 v[32:35], v[176:179], a[64:67], v[32:35]
  buffer_load_dwordx4 v[172:175], v16, s[60:63], s92 offen offset:3072 sc1
  v_mfma_f32_16x16x32_bf16 v[36:39], v[176:179], a[68:71], v[36:39]
  v_mfma_f32_16x16x32_bf16 v[40:43], v[176:179], a[72:75], v[40:43]
  v_mfma_f32_16x16x32_bf16 v[44:47], v[176:179], a[76:79], v[44:47]
  s_waitcnt lgkmcnt(0)
  s_barrier
  s_waitcnt vmcnt(14)
  v_mfma_f32_16x16x32_bf16 v[32:35], v[180:183], a[80:83], v[32:35]
  buffer_load_dwordx4 v[176:179], v16, s[60:63], s93 offen offset:0 sc1
  v_mfma_f32_16x16x32_bf16 v[36:39], v[180:183], a[84:87], v[36:39]
  ds_read_b64 v[72:73], v20 offset:8192
  v_mfma_f32_16x16x32_bf16 v[40:43], v[180:183], a[88:91], v[40:43]
  ds_read_b64 v[74:75], v20 offset:8704
  v_mfma_f32_16x16x32_bf16 v[44:47], v[180:183], a[92:95], v[44:47]
  ds_read_b64 v[76:77], v20 offset:9216
  s_waitcnt vmcnt(14)
  v_mfma_f32_16x16x32_bf16 v[32:35], v[184:187], a[96:99], v[32:35]
  buffer_load_dwordx4 v[180:183], v16, s[60:63], s93 offen offset:1024 sc1
  v_mfma_f32_16x16x32_bf16 v[36:39], v[184:187], a[100:103], v[36:39]
  v_lshlrev_b32 v80, 16, v78
  v_and_b32 v81, s69, v78
  v_mfma_f32_16x16x32_bf16 v[40:43], v[184:187], a[104:107], v[40:43]
  v_lshlrev_b32 v82, 16, v79
  v_and_b32 v83, s69, v79
  v_mfma_f32_16x16x32_bf16 v[44:47], v[184:187], a[108:111], v[44:47]
  s_waitcnt vmcnt(14)
  v_mfma_f32_16x16x32_bf16 v[32:35], v[188:191], a[112:115], v[32:35]
  buffer_load_dwordx4 v[184:187], v16, s[60:63], s93 offen offset:2048 sc1
  v_mfma_f32_16x16x32_bf16 v[36:39], v[188:191], a[116:119], v[36:39]
  v_mfma_f32_16x16x32_bf16 v[40:43], v[188:191], a[120:123], v[40:43]
  s_waitcnt lgkmcnt(0)
  v_mfma_f32_16x16x32_bf16 v[48:51], v[116:119], v[72:75], v[48:51]
  v_mfma_f32_16x16x32_bf16 v[44:47], v[188:191], a[124:127], v[44:47]
  s_waitcnt vmcnt(14)
  v_mfma_f32_16x16x32_bf16 v[32:35], v[192:195], a[128:131], v[32:35]
  buffer_load_dwordx4 v[188:191], v16, s[60:63], s93 offen offset:3072 sc1
  v_mfma_f32_16x16x32_bf16 v[36:39], v[192:195], a[132:135], v[36:39]
  v_mfma_f32_16x16x32_bf16 v[40:43], v[192:195], a[136:139], v[40:43]
  v_mfma_f32_16x16x32_bf16 v[44:47], v[192:195], a[140:143], v[44:47]
  s_waitcnt vmcnt(14)
  v_mfma_f32_16x16x32_bf16 v[32:35], v[196:199], a[144:147], v[32:35]
  buffer_load_dwordx4 v[192:195], v16, s[60:63], s94 offen offset:0 sc1
  v_mfma_f32_16x16x32_bf16 v[36:39], v[196:199], a[148:151], v[36:39]
  v_mfma_f32_16x16x16_bf16 v[48:51], v[116:117], v[76:77], v[48:51]
  v_mfma_f32_16x16x32_bf16 v[40:43], v[196:199], a[152:155], v[40:43]
  v_mfma_f32_16x16x32_bf16 v[44:47], v[196:199], a[156:159], v[44:47]
  s_waitcnt vmcnt(14)
  v_mfma_f32_16x16x32_bf16 v[32:35], v[200:203], a[160:163], v[32:35]
  buffer_load_dwordx4 v[196:199], v16, s[60:63], s94 offen offset:1024 sc1
  v_mfma_f32_16x16x32_bf16 v[36:39], v[200:203], a[164:167], v[36:39]
  v_mfma_f32_16x16x32_bf16 v[40:43], v[200:203], a[168:171], v[40:43]
  v_mfma_f32_16x16x32_bf16 v[44:47], v[200:203], a[172:175], v[44:47]
  s_waitcnt vmcnt(14)
  v_mfma_f32_16x16x32_bf16 v[32:35], v[204:207], a[176:179], v[32:35]
  buffer_load_dwordx4 v[200:203], v16, s[60:63], s94 offen offset:2048 sc1
  v_mfma_f32_16x16x32_bf16 v[36:39], v[204:207], a[180:183], v[36:39]
  v_mul_f32 v80, v80, v48
  v_mul_f32 v81, v81, v49
  v_mfma_f32_16x16x32_bf16 v[40:43], v[204:207], a[184:187], v[40:43]
  v_mul_f32 v82, v82, v50
  v_mul_f32 v83, v83, v51
  v_mfma_f32_16x16x32_bf16 v[44:47], v[204:207], a[188:191], v[44:47]
  s_waitcnt vmcnt(14)
  v_mfma_f32_16x16x32_bf16 v[32:35], v[208:211], a[192:195], v[32:35]
  buffer_load_dwordx4 v[204:207], v16, s[60:63], s94 offen offset:3072 sc1
  v_mfma_f32_16x16x32_bf16 v[36:39], v[208:211], a[196:199], v[36:39]
  v_cvt_pk_bf16_f32 v86, v80, v81
  v_cvt_pk_bf16_f32 v87, v82, v83
  v_mfma_f32_16x16x32_bf16 v[40:43], v[208:211], a[200:203], v[40:43]
  v_mfma_f32_16x16x32_bf16 v[44:47], v[208:211], a[204:207], v[44:47]
  s_waitcnt vmcnt(14)
  v_mfma_f32_16x16x32_bf16 v[32:35], v[212:215], a[208:211], v[32:35]
  buffer_load_dwordx4 v[208:211], v16, s[60:63], s95 offen offset:0 sc1
  v_mfma_f32_16x16x32_bf16 v[36:39], v[212:215], a[212:215], v[36:39]
  v_permlane16_swap_b32 v84, v86
  v_permlane16_swap_b32 v85, v87
  v_mfma_f32_16x16x32_bf16 v[40:43], v[212:215], a[216:219], v[40:43]
  buffer_store_dwordx4 v[84:87], v28, s[60:63], 0 offen offset:0 sc1
  v_mfma_f32_16x16x32_bf16 v[44:47], v[212:215], a[220:223], v[44:47]
  s_waitcnt vmcnt(15)
  v_mfma_f32_16x16x32_bf16 v[32:35], v[216:219], a[224:227], v[32:35]
  buffer_load_dwordx4 v[212:215], v16, s[60:63], s95 offen offset:1024 sc1
  v_mfma_f32_16x16x32_bf16 v[36:39], v[216:219], a[228:231], v[36:39]
  v_mfma_f32_16x16x32_bf16 v[40:43], v[216:219], a[232:235], v[40:43]
  v_mfma_f32_16x16x32_bf16 v[44:47], v[216:219], a[236:239], v[44:47]
  s_waitcnt vmcnt(15)
  v_mfma_f32_16x16x32_bf16 v[32:35], v[220:223], a[240:243], v[32:35]
  buffer_load_dwordx4 v[216:219], v16, s[60:63], s95 offen offset:2048 sc1
  v_mfma_f32_16x16x32_bf16 v[36:39], v[220:223], a[244:247], v[36:39]
  v_mfma_f32_16x16x32_bf16 v[40:43], v[220:223], a[248:251], v[40:43]
  v_mfma_f32_16x16x32_bf16 v[44:47], v[220:223], a[252:255], v[44:47]
  s_waitcnt vmcnt(15)
  v_mfma_f32_16x16x32_bf16 v[48:51], v[160:163], a[0:3], v[112:115]
  buffer_load_dwordx4 v[220:223], v16, s[60:63], s95 offen offset:3072 sc1
  v_add_u32 v16, 0x10000, v16
  v_mfma_f32_16x16x32_bf16 v[52:55], v[160:163], a[4:7], 0
  v_mfma_f32_16x16x32_bf16 v[56:59], v[160:163], a[8:11], 0
  v_mfma_f32_16x16x32_bf16 v[60:63], v[160:163], a[12:15], 0
  s_waitcnt vmcnt(15)
  v_mfma_f32_16x16x32_bf16 v[48:51], v[164:167], a[16:19], v[48:51]
  buffer_load_dwordx4 v[160:163], v16, s[60:63], s92 offen offset:0 sc1
  v_mfma_f32_16x16x32_bf16 v[52:55], v[164:167], a[20:23], v[52:55]
  v_cvt_pk_bf16_f32 v64, v36, v37
  v_cvt_pk_bf16_f32 v65, v38, v39
  v_mfma_f32_16x16x32_bf16 v[56:59], v[164:167], a[24:27], v[56:59]
  v_cvt_pk_bf16_f32 v66, v40, v41
  v_cvt_pk_bf16_f32 v67, v42, v43
  v_mfma_f32_16x16x32_bf16 v[60:63], v[164:167], a[28:31], v[60:63]
  s_waitcnt vmcnt(15)
  v_mfma_f32_16x16x32_bf16 v[48:51], v[168:171], a[32:35], v[48:51]
  buffer_load_dwordx4 v[164:167], v16, s[60:63], s92 offen offset:1024 sc1
  v_mfma_f32_16x16x32_bf16 v[52:55], v[168:171], a[36:39], v[52:55]
  v_cvt_pk_bf16_f32 v68, v44, v45
  v_cvt_pk_bf16_f32 v69, v46, v47
  v_mfma_f32_16x16x32_bf16 v[56:59], v[168:171], a[40:43], v[56:59]
  ds_write_b64 v17, v[64:65] offset:0
  v_mfma_f32_16x16x32_bf16 v[60:63], v[168:171], a[44:47], v[60:63]
  ds_write_b64 v18, v[66:67] offset:0
  s_waitcnt vmcnt(15)
  v_mfma_f32_16x16x32_bf16 v[48:51], v[172:175], a[48:51], v[48:51]
  buffer_load_dwordx4 v[168:171], v16, s[60:63], s92 offen offset:2048 sc1
  v_mfma_f32_16x16x32_bf16 v[52:55], v[172:175], a[52:55], v[52:55]
  ds_write_b64 v19, v[68:69] offset:0
  v_mfma_f32_16x16x32_bf16 v[56:59], v[172:175], a[56:59], v[56:59]
  ds_read_b64 v[78:79], v21 offset:1024
  v_mfma_f32_16x16x32_bf16 v[60:63], v[172:175], a[60:63], v[60:63]
  s_waitcnt vmcnt(15)
  v_mfma_f32_16x16x32_bf16 v[48:51], v[176:179], a[64:67], v[48:51]
  buffer_load_dwordx4 v[172:175], v16, s[60:63], s92 offen offset:3072 sc1
  v_mfma_f32_16x16x32_bf16 v[52:55], v[176:179], a[68:71], v[52:55]
  v_mfma_f32_16x16x32_bf16 v[56:59], v[176:179], a[72:75], v[56:59]
  v_mfma_f32_16x16x32_bf16 v[60:63], v[176:179], a[76:79], v[60:63]
  s_waitcnt lgkmcnt(0)
  s_barrier
  s_waitcnt vmcnt(15)
  v_mfma_f32_16x16x32_bf16 v[48:51], v[180:183], a[80:83], v[48:51]
  buffer_load_dwordx4 v[176:179], v16, s[60:63], s93 offen offset:0 sc1
  v_mfma_f32_16x16x32_bf16 v[52:55], v[180:183], a[84:87], v[52:55]
  ds_read_b64 v[72:73], v20 offset:0
  v_mfma_f32_16x16x32_bf16 v[56:59], v[180:183], a[88:91], v[56:59]
  ds_read_b64 v[74:75], v20 offset:512
  v_mfma_f32_16x16x32_bf16 v[60:63], v[180:183], a[92:95], v[60:63]
  ds_read_b64 v[76:77], v20 offset:1024
  s_waitcnt vmcnt(15)
  v_mfma_f32_16x16x32_bf16 v[48:51], v[184:187], a[96:99], v[48:51]
  buffer_load_dwordx4 v[180:183], v16, s[60:63], s93 offen offset:1024 sc1
  v_mfma_f32_16x16x32_bf16 v[52:55], v[184:187], a[100:103], v[52:55]
  v_lshlrev_b32 v80, 16, v78
  v_and_b32 v81, s69, v78
  v_mfma_f32_16x16x32_bf16 v[56:59], v[184:187], a[104:107], v[56:59]
  v_lshlrev_b32 v82, 16, v79
  v_and_b32 v83, s69, v79
  v_mfma_f32_16x16x32_bf16 v[60:63], v[184:187], a[108:111], v[60:63]
  s_waitcnt vmcnt(15)
  v_mfma_f32_16x16x32_bf16 v[48:51], v[188:191], a[112:115], v[48:51]
  buffer_load_dwordx4 v[184:187], v16, s[60:63], s93 offen offset:2048 sc1
  v_mfma_f32_16x16x32_bf16 v[52:55], v[188:191], a[116:119], v[52:55]
  v_mfma_f32_16x16x32_bf16 v[56:59], v[188:191], a[120:123], v[56:59]
  s_waitcnt lgkmcnt(0)
  v_mfma_f32_16x16x32_bf16 v[32:35], v[116:119], v[72:75], v[32:35]
  v_mfma_f32_16x16x32_bf16 v[60:63], v[188:191], a[124:127], v[60:63]
  s_waitcnt vmcnt(15)
  v_mfma_f32_16x16x32_bf16 v[48:51], v[192:195], a[128:131], v[48:51]
  buffer_load_dwordx4 v[188:191], v16, s[60:63], s93 offen offset:3072 sc1
  v_mfma_f32_16x16x32_bf16 v[52:55], v[192:195], a[132:135], v[52:55]
  v_mfma_f32_16x16x32_bf16 v[56:59], v[192:195], a[136:139], v[56:59]
  v_mfma_f32_16x16x32_bf16 v[60:63], v[192:195], a[140:143], v[60:63]
  s_waitcnt vmcnt(15)
  v_mfma_f32_16x16x32_bf16 v[48:51], v[196:199], a[144:147], v[48:51]
  buffer_load_dwordx4 v[192:195], v16, s[60:63], s94 offen offset:0 sc1
  v_mfma_f32_16x16x32_bf16 v[52:55], v[196:199], a[148:151], v[52:55]
  v_mfma_f32_16x16x16_bf16 v[32:35], v[116:117], v[76:77], v[32:35]
  v_mfma_f32_16x16x32_bf16 v[56:59], v[196:199], a[152:155], v[56:59]
  v_mfma_f32_16x16x32_bf16 v[60:63], v[196:199], a[156:159], v[60:63]
  s_waitcnt vmcnt(15)
  v_mfma_f32_16x16x32_bf16 v[48:51], v[200:203], a[160:163], v[48:51]
  buffer_load_dwordx4 v[196:199], v16, s[60:63], s94 offen offset:1024 sc1
  v_mfma_f32_16x16x32_bf16 v[52:55], v[200:203], a[164:167], v[52:55]
  v_mfma_f32_16x16x32_bf16 v[56:59], v[200:203], a[168:171], v[56:59]
  v_mfma_f32_16x16x32_bf16 v[60:63], v[200:203], a[172:175], v[60:63]
  s_waitcnt vmcnt(15)
  v_mfma_f32_16x16x32_bf16 v[48:51], v[204:207], a[176:179], v[48:51]
  buffer_load_dwordx4 v[200:203], v16, s[60:63], s94 offen offset:2048 sc1
  v_mfma_f32_16x16x32_bf16 v[52:55], v[204:207], a[180:183], v[52:55]
  v_mul_f32 v80, v80, v32
  v_mul_f32 v81, v81, v33
  v_mfma_f32_16x16x32_bf16 v[56:59], v[204:207], a[184:187], v[56:59]
  v_mul_f32 v82, v82, v34
  v_mul_f32 v83, v83, v35
  v_mfma_f32_16x16x32_bf16 v[60:63], v[204:207], a[188:191], v[60:63]
  s_waitcnt vmcnt(15)
  v_mfma_f32_16x16x32_bf16 v[48:51], v[208:211], a[192:195], v[48:51]
  buffer_load_dwordx4 v[204:207], v16, s[60:63], s94 offen offset:3072 sc1
  v_mfma_f32_16x16x32_bf16 v[52:55], v[208:211], a[196:199], v[52:55]
  v_cvt_pk_bf16_f32 v88, v80, v81
  v_cvt_pk_bf16_f32 v89, v82, v83
  v_mfma_f32_16x16x32_bf16 v[56:59], v[208:211], a[200:203], v[56:59]
  v_mfma_f32_16x16x32_bf16 v[60:63], v[208:211], a[204:207], v[60:63]
  s_waitcnt vmcnt(14)
  v_mfma_f32_16x16x32_bf16 v[48:51], v[212:215], a[208:211], v[48:51]
  buffer_load_dwordx4 v[208:211], v16, s[60:63], s95 offen offset:0 sc1
  v_mfma_f32_16x16x32_bf16 v[52:55], v[212:215], a[212:215], v[52:55]
  v_mfma_f32_16x16x32_bf16 v[56:59], v[212:215], a[216:219], v[56:59]
  v_mfma_f32_16x16x32_bf16 v[60:63], v[212:215], a[220:223], v[60:63]
  s_waitcnt vmcnt(14)
  v_mfma_f32_16x16x32_bf16 v[48:51], v[216:219], a[224:227], v[48:51]
  buffer_load_dwordx4 v[212:215], v16, s[60:63], s95 offen offset:1024 sc1
  v_mfma_f32_16x16x32_bf16 v[52:55], v[216:219], a[228:231], v[52:55]
  v_mfma_f32_16x16x32_bf16 v[56:59], v[216:219], a[232:235], v[56:59]
  v_mfma_f32_16x16x32_bf16 v[60:63], v[216:219], a[236:239], v[60:63]
  s_waitcnt vmcnt(14)
  v_mfma_f32_16x16x32_bf16 v[48:51], v[220:223], a[240:243], v[48:51]
  buffer_load_dwordx4 v[216:219], v16, s[60:63], s95 offen offset:2048 sc1
  v_mfma_f32_16x16x32_bf16 v[52:55], v[220:223], a[244:247], v[52:55]
  v_mfma_f32_16x16x32_bf16 v[56:59], v[220:223], a[248:251], v[56:59]
  v_mfma_f32_16x16x32_bf16 v[60:63], v[220:223], a[252:255], v[60:63]
  s_waitcnt vmcnt(14)
  v_mfma_f32_16x16x32_bf16 v[32:35], v[160:163], a[0:3], v[112:115]
  buffer_load_dwordx4 v[220:223], v16, s[60:63], s95 offen offset:3072 sc1
  v_add_u32 v16, 0x10000, v16
  v_mfma_f32_16x16x32_bf16 v[36:39], v[160:163], a[4:7], 0
  v_mfma_f32_16x16x32_bf16 v[40:43], v[160:163], a[8:11], 0
  v_mfma_f32_16x16x32_bf16 v[44:47], v[160:163], a[12:15], 0
  s_waitcnt vmcnt(14)
  v_mfma_f32_16x16x32_bf16 v[32:35], v[164:167], a[16:19], v[32:35]
  buffer_load_dwordx4 v[160:163], v16, s[60:63], s92 offen offset:0 sc1
  v_mfma_f32_16x16x32_bf16 v[36:39], v[164:167], a[20:23], v[36:39]
  v_cvt_pk_bf16_f32 v64, v52, v53
  v_cvt_pk_bf16_f32 v65, v54, v55
  v_mfma_f32_16x16x32_bf16 v[40:43], v[164:167], a[24:27], v[40:43]
  v_cvt_pk_bf16_f32 v66, v56, v57
  v_cvt_pk_bf16_f32 v67, v58, v59
  v_mfma_f32_16x16x32_bf16 v[44:47], v[164:167], a[28:31], v[44:47]
  s_waitcnt vmcnt(14)
  v_mfma_f32_16x16x32_bf16 v[32:35], v[168:171], a[32:35], v[32:35]
  buffer_load_dwordx4 v[164:167], v16, s[60:63], s92 offen offset:1024 sc1
  v_mfma_f32_16x16x32_bf16 v[36:39], v[168:171], a[36:39], v[36:39]
  v_cvt_pk_bf16_f32 v68, v60, v61
  v_cvt_pk_bf16_f32 v69, v62, v63
  v_mfma_f32_16x16x32_bf16 v[40:43], v[168:171], a[40:43], v[40:43]
  ds_write_b64 v17, v[64:65] offset:8192
  v_mfma_f32_16x16x32_bf16 v[44:47], v[168:171], a[44:47], v[44:47]
  ds_write_b64 v18, v[66:67] offset:8192
  s_waitcnt vmcnt(14)
  v_mfma_f32_16x16x32_bf16 v[32:35], v[172:175], a[48:51], v[32:35]
  buffer_load_dwordx4 v[168:171], v16, s[60:63], s92 offen offset:2048 sc1
  v_mfma_f32_16x16x32_bf16 v[36:39], v[172:175], a[52:55], v[36:39]
  ds_write_b64 v19, v[68:69] offset:8192
  v_mfma_f32_16x16x32_bf16 v[40:43], v[172:175], a[56:59], v[40:43]
  ds_read_b64 v[78:79], v21 offset:1536
  v_mfma_f32_16x16x32_bf16 v[44:47], v[172:175], a[60:63], v[44:47]
  s_waitcnt vmcnt(14)
  v_mfma_f32_16x16x32_bf16 v[32:35], v[176:179], a[64:67], v[32:35]
  buffer_load_dwordx4 v[172:175], v16, s[60:63], s92 offen offset:3072 sc1
  v_mfma_f32_16x16x32_bf16 v[36:39], v[176:179], a[68:71], v[36:39]
  v_mfma_f32_16x16x32_bf16 v[40:43], v[176:179], a[72:75], v[40:43]
  v_mfma_f32_16x16x32_bf16 v[44:47], v[176:179], a[76:79], v[44:47]
  s_waitcnt lgkmcnt(0)
  s_barrier
  s_waitcnt vmcnt(14)
  v_mfma_f32_16x16x32_bf16 v[32:35], v[180:183], a[80:83], v[32:35]
  buffer_load_dwordx4 v[176:179], v16, s[60:63], s93 offen offset:0 sc1
  v_mfma_f32_16x16x32_bf16 v[36:39], v[180:183], a[84:87], v[36:39]
  ds_read_b64 v[72:73], v20 offset:8192
  v_mfma_f32_16x16x32_bf16 v[40:43], v[180:183], a[88:91], v[40:43]
  ds_read_b64 v[74:75], v20 offset:8704
  v_mfma_f32_16x16x32_bf16 v[44:47], v[180:183], a[92:95], v[44:47]
  ds_read_b64 v[76:77], v20 offset:9216
  s_waitcnt vmcnt(14)
  v_mfma_f32_16x16x32_bf16 v[32:35], v[184:187], a[96:99], v[32:35]
  buffer_load_dwordx4 v[180:183], v16, s[60:63], s93 offen offset:1024 sc1
  v_mfma_f32_16x16x32_bf16 v[36:39], v[184:187], a[100:103], v[36:39]
  v_lshlrev_b32 v80, 16, v78
  v_and_b32 v81, s69, v78
  v_mfma_f32_16x16x32_bf16 v[40:43], v[184:187], a[104:107], v[40:43]
  v_lshlrev_b32 v82, 16, v79
  v_and_b32 v83, s69, v79
  v_mfma_f32_16x16x32_bf16 v[44:47], v[184:187], a[108:111], v[44:47]
  s_waitcnt vmcnt(14)
  v_mfma_f32_16x16x32_bf16 v[32:35], v[188:191], a[112:115], v[32:35]
  buffer_load_dwordx4 v[184:187], v16, s[60:63], s93 offen offset:2048 sc1
  v_mfma_f32_16x16x32_bf16 v[36:39], v[188:191], a[116:119], v[36:39]
  v_mfma_f32_16x16x32_bf16 v[40:43], v[188:191], a[120:123], v[40:43]
  s_waitcnt lgkmcnt(0)
  v_mfma_f32_16x16x32_bf16 v[48:51], v[116:119], v[72:75], v[48:51]
  v_mfma_f32_16x16x32_bf16 v[44:47], v[188:191], a[124:127], v[44:47]
  s_waitcnt vmcnt(14)
  v_mfma_f32_16x16x32_bf16 v[32:35], v[192:195], a[128:131], v[32:35]
  buffer_load_dwordx4 v[188:191], v16, s[60:63], s93 offen offset:3072 sc1
  v_mfma_f32_16x16x32_bf16 v[36:39], v[192:195], a[132:135], v[36:39]
  v_mfma_f32_16x16x32_bf16 v[40:43], v[192:195], a[136:139], v[40:43]
  v_mfma_f32_16x16x32_bf16 v[44:47], v[192:195], a[140:143], v[44:47]
  s_waitcnt vmcnt(14)
  v_mfma_f32_16x16x32_bf16 v[32:35], v[196:199], a[144:147], v[32:35]
  buffer_load_dwordx4 v[192:195], v16, s[60:63], s94 offen offset:0 sc1
  v_mfma_f32_16x16x32_bf16 v[36:39], v[196:199], a[148:151], v[36:39]
  v_mfma_f32_16x16x16_bf16 v[48:51], v[116:117], v[76:77], v[48:51]
  v_mfma_f32_16x16x32_bf16 v[40:43], v[196:199], a[152:155], v[40:43]
  v_mfma_f32_16x16x32_bf16 v[44:47], v[196:199], a[156:159], v[44:47]
  s_waitcnt vmcnt(14)
  v_mfma_f32_16x16x32_bf16 v[32:35], v[200:203], a[160:163], v[32:35]
  buffer_load_dwordx4 v[196:199], v16, s[60:63], s94 offen offset:1024 sc1
  v_mfma_f32_16x16x32_bf16 v[36:39], v[200:203], a[164:167], v[36:39]
  v_mfma_f32_16x16x32_bf16 v[40:43], v[200:203], a[168:171], v[40:43]
  v_mfma_f32_16x16x32_bf16 v[44:47], v[200:203], a[172:175], v[44:47]
  s_waitcnt vmcnt(14)
  v_mfma_f32_16x16x32_bf16 v[32:35], v[204:207], a[176:179], v[32:35]
  buffer_load_dwordx4 v[200:203], v16, s[60:63], s94 offen offset:2048 sc1
  v_mfma_f32_16x16x32_bf16 v[36:39], v[204:207], a[180:183], v[36:39]
  v_mul_f32 v80, v80, v48
  v_mul_f32 v81, v81, v49
  v_mfma_f32_16x16x32_bf16 v[40:43], v[204:207], a[184:187], v[40:43]
  v_mul_f32 v82, v82, v50
  v_mul_f32 v83, v83, v51
  v_mfma_f32_16x16x32_bf16 v[44:47], v[204:207], a[188:191], v[44:47]
  s_waitcnt vmcnt(14)
  v_mfma_f32_16x16x32_bf16 v[32:35], v[208:211], a[192:195], v[32:35]
  buffer_load_dwordx4 v[204:207], v16, s[60:63], s94 offen offset:3072 sc1
  v_mfma_f32_16x16x32_bf16 v[36:39], v[208:211], a[196:199], v[36:39]
  v_cvt_pk_bf16_f32 v90, v80, v81
  v_cvt_pk_bf16_f32 v91, v82, v83
  v_mfma_f32_16x16x32_bf16 v[40:43], v[208:211], a[200:203], v[40:43]
  v_mfma_f32_16x16x32_bf16 v[44:47], v[208:211], a[204:207], v[44:47]
  s_waitcnt vmcnt(14)
  v_mfma_f32_16x16x32_bf16 v[32:35], v[212:215], a[208:211], v[32:35]
  buffer_load_dwordx4 v[208:211], v16, s[60:63], s95 offen offset:0 sc1
  v_mfma_f32_16x16x32_bf16 v[36:39], v[212:215], a[212:215], v[36:39]
  v_permlane16_swap_b32 v88, v90
  v_permlane16_swap_b32 v89, v91
  v_mfma_f32_16x16x32_bf16 v[40:43], v[212:215], a[216:219], v[40:43]
  buffer_store_dwordx4 v[88:91], v28, s[60:63], 0 offen offset:1024 sc1
  v_mfma_f32_16x16x32_bf16 v[44:47], v[212:215], a[220:223], v[44:47]
  s_waitcnt vmcnt(15)
  v_mfma_f32_16x16x32_bf16 v[32:35], v[216:219], a[224:227], v[32:35]
  buffer_load_dwordx4 v[212:215], v16, s[60:63], s95 offen offset:1024 sc1
  v_mfma_f32_16x16x32_bf16 v[36:39], v[216:219], a[228:231], v[36:39]
  v_mfma_f32_16x16x32_bf16 v[40:43], v[216:219], a[232:235], v[40:43]
  v_mfma_f32_16x16x32_bf16 v[44:47], v[216:219], a[236:239], v[44:47]
  s_waitcnt vmcnt(15)
  v_mfma_f32_16x16x32_bf16 v[32:35], v[220:223], a[240:243], v[32:35]
  buffer_load_dwordx4 v[216:219], v16, s[60:63], s95 offen offset:2048 sc1
  v_mfma_f32_16x16x32_bf16 v[36:39], v[220:223], a[244:247], v[36:39]
  v_mfma_f32_16x16x32_bf16 v[40:43], v[220:223], a[248:251], v[40:43]
  v_mfma_f32_16x16x32_bf16 v[44:47], v[220:223], a[252:255], v[44:47]
  s_waitcnt vmcnt(15)
  v_mfma_f32_16x16x32_bf16 v[48:51], v[160:163], a[0:3], v[112:115]
  buffer_load_dwordx4 v[220:223], v16, s[60:63], s95 offen offset:3072 sc1
  v_add_u32 v16, 0x10000, v16
  v_mfma_f32_16x16x32_bf16 v[52:55], v[160:163], a[4:7], 0
  v_mfma_f32_16x16x32_bf16 v[56:59], v[160:163], a[8:11], 0
  v_mfma_f32_16x16x32_bf16 v[60:63], v[160:163], a[12:15], 0
  s_waitcnt vmcnt(15)
  v_mfma_f32_16x16x32_bf16 v[48:51], v[164:167], a[16:19], v[48:51]
  buffer_load_dwordx4 v[160:163], v16, s[60:63], s92 offen offset:0 sc1
  v_mfma_f32_16x16x32_bf16 v[52:55], v[164:167], a[20:23], v[52:55]
  v_cvt_pk_bf16_f32 v64, v36, v37
  v_cvt_pk_bf16_f32 v65, v38, v39
  v_mfma_f32_16x16x32_bf16 v[56:59], v[164:167], a[24:27], v[56:59]
  v_cvt_pk_bf16_f32 v66, v40, v41
  v_cvt_pk_bf16_f32 v67, v42, v43
  v_mfma_f32_16x16x32_bf16 v[60:63], v[164:167], a[28:31], v[60:63]
  s_waitcnt vmcnt(15)
  v_mfma_f32_16x16x32_bf16 v[48:51], v[168:171], a[32:35], v[48:51]
  buffer_load_dwordx4 v[164:167], v16, s[60:63], s92 offen offset:1024 sc1
  v_mfma_f32_16x16x32_bf16 v[52:55], v[168:171], a[36:39], v[52:55]
  v_cvt_pk_bf16_f32 v68, v44, v45
  v_cvt_pk_bf16_f32 v69, v46, v47
  v_mfma_f32_16x16x32_bf16 v[56:59], v[168:171], a[40:43], v[56:59]
  ds_write_b64 v17, v[64:65] offset:0
  v_mfma_f32_16x16x32_bf16 v[60:63], v[168:171], a[44:47], v[60:63]
  ds_write_b64 v18, v[66:67] offset:0
  s_waitcnt vmcnt(15)
  v_mfma_f32_16x16x32_bf16 v[48:51], v[172:175], a[48:51], v[48:51]
  buffer_load_dwordx4 v[168:171], v16, s[60:63], s92 offen offset:2048 sc1
  v_mfma_f32_16x16x32_bf16 v[52:55], v[172:175], a[52:55], v[52:55]
  ds_write_b64 v19, v[68:69] offset:0
  v_mfma_f32_16x16x32_bf16 v[56:59], v[172:175], a[56:59], v[56:59]
  ds_read_b64 v[78:79], v21 offset:2048
  v_mfma_f32_16x16x32_bf16 v[60:63], v[172:175], a[60:63], v[60:63]
  s_waitcnt vmcnt(15)
  v_mfma_f32_16x16x32_bf16 v[48:51], v[176:179], a[64:67], v[48:51]
  buffer_load_dwordx4 v[172:175], v16, s[60:63], s92 offen offset:3072 sc1
  v_mfma_f32_16x16x32_bf16 v[52:55], v[176:179], a[68:71], v[52:55]
  v_mfma_f32_16x16x32_bf16 v[56:59], v[176:179], a[72:75], v[56:59]
  v_mfma_f32_16x16x32_bf16 v[60:63], v[176:179], a[76:79], v[60:63]
  s_waitcnt lgkmcnt(0)
  s_barrier
  s_waitcnt vmcnt(15)
  v_mfma_f32_16x16x32_bf16 v[48:51], v[180:183], a[80:83], v[48:51]
  buffer_load_dwordx4 v[176:179], v16, s[60:63], s93 offen offset:0 sc1
  v_mfma_f32_16x16x32_bf16 v[52:55], v[180:183], a[84:87], v[52:55]
  ds_read_b64 v[72:73], v20 offset:0
  v_mfma_f32_16x16x32_bf16 v[56:59], v[180:183], a[88:91], v[56:59]
  ds_read_b64 v[74:75], v20 offset:512
  v_mfma_f32_16x16x32_bf16 v[60:63], v[180:183], a[92:95], v[60:63]
  ds_read_b64 v[76:77], v20 offset:1024
  s_waitcnt vmcnt(15)
  v_mfma_f32_16x16x32_bf16 v[48:51], v[184:187], a[96:99], v[48:51]
  buffer_load_dwordx4 v[180:183], v16, s[60:63], s93 offen offset:1024 sc1
  v_mfma_f32_16x16x32_bf16 v[52:55], v[184:187], a[100:103], v[52:55]
  v_lshlrev_b32 v80, 16, v78
  v_and_b32 v81, s69, v78
  v_mfma_f32_16x16x32_bf16 v[56:59], v[184:187], a[104:107], v[56:59]
  v_lshlrev_b32 v82, 16, v79
  v_and_b32 v83, s69, v79
  v_mfma_f32_16x16x32_bf16 v[60:63], v[184:187], a[108:111], v[60:63]
  s_waitcnt vmcnt(15)
  v_mfma_f32_16x16x32_bf16 v[48:51], v[188:191], a[112:115], v[48:51]
  buffer_load_dwordx4 v[184:187], v16, s[60:63], s93 offen offset:2048 sc1
  v_mfma_f32_16x16x32_bf16 v[52:55], v[188:191], a[116:119], v[52:55]
  v_mfma_f32_16x16x32_bf16 v[56:59], v[188:191], a[120:123], v[56:59]
  s_waitcnt lgkmcnt(0)
  v_mfma_f32_16x16x32_bf16 v[32:35], v[116:119], v[72:75], v[32:35]
  v_mfma_f32_16x16x32_bf16 v[60:63], v[188:191], a[124:127], v[60:63]
  s_waitcnt vmcnt(15)
  v_mfma_f32_16x16x32_bf16 v[48:51], v[192:195], a[128:131], v[48:51]
  buffer_load_dwordx4 v[188:191], v16, s[60:63], s93 offen offset:3072 sc1
  v_mfma_f32_16x16x32_bf16 v[52:55], v[192:195], a[132:135], v[52:55]
  v_mfma_f32_16x16x32_bf16 v[56:59], v[192:195], a[136:139], v[56:59]
  v_mfma_f32_16x16x32_bf16 v[60:63], v[192:195], a[140:143], v[60:63]
  s_waitcnt vmcnt(15)
  v_mfma_f32_16x16x32_bf16 v[48:51], v[196:199], a[144:147], v[48:51]
  buffer_load_dwordx4 v[192:195], v16, s[60:63], s94 offen offset:0 sc1
  v_mfma_f32_16x16x32_bf16 v[52:55], v[196:199], a[148:151], v[52:55]
  v_mfma_f32_16x16x16_bf16 v[32:35], v[116:117], v[76:77], v[32:35]
  v_mfma_f32_16x16x32_bf16 v[56:59], v[196:199], a[152:155], v[56:59]
  v_mfma_f32_16x16x32_bf16 v[60:63], v[196:199], a[156:159], v[60:63]
  s_waitcnt vmcnt(15)
  v_mfma_f32_16x16x32_bf16 v[48:51], v[200:203], a[160:163], v[48:51]
  buffer_load_dwordx4 v[196:199], v16, s[60:63], s94 offen offset:1024 sc1
  v_mfma_f32_16x16x32_bf16 v[52:55], v[200:203], a[164:167], v[52:55]
  v_mfma_f32_16x16x32_bf16 v[56:59], v[200:203], a[168:171], v[56:59]
  v_mfma_f32_16x16x32_bf16 v[60:63], v[200:203], a[172:175], v[60:63]
  s_waitcnt vmcnt(15)
  v_mfma_f32_16x16x32_bf16 v[48:51], v[204:207], a[176:179], v[48:51]
  buffer_load_dwordx4 v[200:203], v16, s[60:63], s94 offen offset:2048 sc1
  v_mfma_f32_16x16x32_bf16 v[52:55], v[204:207], a[180:183], v[52:55]
  v_mul_f32 v80, v80, v32
  v_mul_f32 v81, v81, v33
  v_mfma_f32_16x16x32_bf16 v[56:59], v[204:207], a[184:187], v[56:59]
  v_mul_f32 v82, v82, v34
  v_mul_f32 v83, v83, v35
  v_mfma_f32_16x16x32_bf16 v[60:63], v[204:207], a[188:191], v[60:63]
  s_waitcnt vmcnt(15)
  v_mfma_f32_16x16x32_bf16 v[48:51], v[208:211], a[192:195], v[48:51]
  buffer_load_dwordx4 v[204:207], v16, s[60:63], s94 offen offset:3072 sc1
  v_mfma_f32_16x16x32_bf16 v[52:55], v[208:211], a[196:199], v[52:55]
  v_cvt_pk_bf16_f32 v84, v80, v81
  v_cvt_pk_bf16_f32 v85, v82, v83
  v_mfma_f32_16x16x32_bf16 v[56:59], v[208:211], a[200:203], v[56:59]
  v_mfma_f32_16x16x32_bf16 v[60:63], v[208:211], a[204:207], v[60:63]
  s_waitcnt vmcnt(14)
  v_mfma_f32_16x16x32_bf16 v[48:51], v[212:215], a[208:211], v[48:51]
  buffer_load_dwordx4 v[208:211], v16, s[60:63], s95 offen offset:0 sc1
  v_mfma_f32_16x16x32_bf16 v[52:55], v[212:215], a[212:215], v[52:55]
  v_mfma_f32_16x16x32_bf16 v[56:59], v[212:215], a[216:219], v[56:59]
  v_mfma_f32_16x16x32_bf16 v[60:63], v[212:215], a[220:223], v[60:63]
  s_waitcnt vmcnt(14)
  v_mfma_f32_16x16x32_bf16 v[48:51], v[216:219], a[224:227], v[48:51]
  buffer_load_dwordx4 v[212:215], v16, s[60:63], s95 offen offset:1024 sc1
  v_mfma_f32_16x16x32_bf16 v[52:55], v[216:219], a[228:231], v[52:55]
  v_mfma_f32_16x16x32_bf16 v[56:59], v[216:219], a[232:235], v[56:59]
  v_mfma_f32_16x16x32_bf16 v[60:63], v[216:219], a[236:239], v[60:63]
  s_waitcnt vmcnt(14)
  v_mfma_f32_16x16x32_bf16 v[48:51], v[220:223], a[240:243], v[48:51]
  buffer_load_dwordx4 v[216:219], v16, s[60:63], s95 offen offset:2048 sc1
  v_mfma_f32_16x16x32_bf16 v[52:55], v[220:223], a[244:247], v[52:55]
  v_mfma_f32_16x16x32_bf16 v[56:59], v[220:223], a[248:251], v[56:59]
  v_mfma_f32_16x16x32_bf16 v[60:63], v[220:223], a[252:255], v[60:63]
  s_waitcnt vmcnt(14)
  v_mfma_f32_16x16x32_bf16 v[32:35], v[160:163], a[0:3], v[112:115]
  buffer_load_dwordx4 v[220:223], v16, s[60:63], s95 offen offset:3072 sc1
  v_add_u32 v16, 0x10000, v16
  v_mfma_f32_16x16x32_bf16 v[36:39], v[160:163], a[4:7], 0
  v_mfma_f32_16x16x32_bf16 v[40:43], v[160:163], a[8:11], 0
  v_mfma_f32_16x16x32_bf16 v[44:47], v[160:163], a[12:15], 0
  s_waitcnt vmcnt(14)
  v_mfma_f32_16x16x32_bf16 v[32:35], v[164:167], a[16:19], v[32:35]
  s_add_u32 m0, s89, 0
  s_mov_b32 s90, 0
  buffer_load_dwordx4 v7, s[40:43], s90 offen lds
  v_mfma_f32_16x16x32_bf16 v[36:39], v[164:167], a[20:23], v[36:39]
  v_cvt_pk_bf16_f32 v64, v52, v53
  v_cvt_pk_bf16_f32 v65, v54, v55
  v_mfma_f32_16x16x32_bf16 v[40:43], v[164:167], a[24:27], v[40:43]
  v_cvt_pk_bf16_f32 v66, v56, v57
  v_cvt_pk_bf16_f32 v67, v58, v59
  v_mfma_f32_16x16x32_bf16 v[44:47], v[164:167], a[28:31], v[44:47]
  s_waitcnt vmcnt(14)
  v_mfma_f32_16x16x32_bf16 v[32:35], v[168:171], a[32:35], v[32:35]
  s_add_u32 m0, s89, 4096
  s_mov_b32 s90, 32768
  buffer_load_dwordx4 v7, s[40:43], s90 offen lds
  v_mfma_f32_16x16x32_bf16 v[36:39], v[168:171], a[36:39], v[36:39]
  v_cvt_pk_bf16_f32 v68, v60, v61
  v_cvt_pk_bf16_f32 v69, v62, v63
  v_mfma_f32_16x16x32_bf16 v[40:43], v[168:171], a[40:43], v[40:43]
  ds_write_b64 v17, v[64:65] offset:8192
  v_mfma_f32_16x16x32_bf16 v[44:47], v[168:171], a[44:47], v[44:47]
  ds_write_b64 v18, v[66:67] offset:8192
  s_waitcnt vmcnt(14)
  v_mfma_f32_16x16x32_bf16 v[32:35], v[172:175], a[48:51], v[32:35]
  s_add_u32 m0, s89, 8192
  s_mov_b32 s90, 65536
  buffer_load_dwordx4 v7, s[40:43], s90 offen lds
  v_mfma_f32_16x16x32_bf16 v[36:39], v[172:175], a[52:55], v[36:39]
  ds_write_b64 v19, v[68:69] offset:8192
  v_mfma_f32_16x16x32_bf16 v[40:43], v[172:175], a[56:59], v[40:43]
  ds_read_b64 v[78:79], v21 offset:2560
  v_mfma_f32_16x16x32_bf16 v[44:47], v[172:175], a[60:63], v[44:47]
  s_waitcnt vmcnt(14)
  v_mfma_f32_16x16x32_bf16 v[32:35], v[176:179], a[64:67], v[32:35]
  s_add_u32 m0, s89, 12288
  s_mov_b32 s90, 114688
  buffer_load_dwordx4 v7, s[40:43], s90 offen lds
  v_mfma_f32_16x16x32_bf16 v[36:39], v[176:179], a[68:71], v[36:39]
  v_mfma_f32_16x16x32_bf16 v[40:43], v[176:179], a[72:75], v[40:43]
  v_mfma_f32_16x16x32_bf16 v[44:47], v[176:179], a[76:79], v[44:47]
  s_waitcnt lgkmcnt(0)
  s_barrier
  s_waitcnt vmcnt(14)
  v_mfma_f32_16x16x32_bf16 v[32:35], v[180:183], a[80:83], v[32:35]
  s_add_u32 m0, s89, 16384
  s_mov_b32 s90, 147456
  buffer_load_dwordx4 v7, s[40:43], s90 offen lds
  v_mfma_f32_16x16x32_bf16 v[36:39], v[180:183], a[84:87], v[36:39]
  s_cmp_eq_u32 s66, 0
  s_cbranch_scc0 L_ow_31
  s_mov_b64 exec, 1
  buffer_atomic_add v23, v22, s[60:63], 0 offen offset:128 sc1
  s_mov_b64 exec, -1
L_ow_31:
  v_mfma_f32_16x16x32_bf16 v[40:43], v[180:183], a[88:91], v[40:43]
  ds_read_b64 v[72:73], v20 offset:8192
  v_mfma_f32_16x16x32_bf16 v[44:47], v[180:183], a[92:95], v[44:47]
  ds_read_b64 v[74:75], v20 offset:8704
  s_waitcnt vmcnt(14)
  v_mfma_f32_16x16x32_bf16 v[32:35], v[184:187], a[96:99], v[32:35]
  s_add_u32 m0, s89, 20480
  s_mov_b32 s90, 180224
  buffer_load_dwordx4 v7, s[40:43], s90 offen lds
  v_mfma_f32_16x16x32_bf16 v[36:39], v[184:187], a[100:103], v[36:39]
  ds_read_b64 v[76:77], v20 offset:9216
  v_mfma_f32_16x16x32_bf16 v[40:43], v[184:187], a[104:107], v[40:43]
  v_lshlrev_b32 v80, 16, v78
  v_and_b32 v81, s69, v78
  v_mfma_f32_16x16x32_bf16 v[44:47], v[184:187], a[108:111], v[44:47]
  s_waitcnt vmcnt(14)
  v_mfma_f32_16x16x32_bf16 v[32:35], v[188:191], a[112:115], v[32:35]
  s_add_u32 m0, s89, 24576
  s_mov_b32 s90, 229376
  buffer_load_dwordx4 v7, s[40:43], s90 offen lds
  v_mfma_f32_16x16x32_bf16 v[36:39], v[188:191], a[116:119], v[36:39]
  v_lshlrev_b32 v82, 16, v79
  v_and_b32 v83, s69, v79
  v_mfma_f32_16x16x32_bf16 v[40:43], v[188:191], a[120:123], v[40:43]
  v_mfma_f32_16x16x32_bf16 v[44:47], v[188:191], a[124:127], v[44:47]
  s_waitcnt vmcnt(14)
  v_mfma_f32_16x16x32_bf16 v[32:35], v[192:195], a[128:131], v[32:35]
  s_add_u32 m0, s89, 28672
  s_mov_b32 s90, 262144
  buffer_load_dwordx4 v7, s[40:43], s90 offen lds
  v_mfma_f32_16x16x32_bf16 v[36:39], v[192:195], a[132:135], v[36:39]
  s_waitcnt lgkmcnt(0)
  v_mfma_f32_16x16x32_bf16 v[48:51], v[116:119], v[72:75], v[48:51]
  v_mfma_f32_16x16x32_bf16 v[40:43], v[192:195], a[136:139], v[40:43]
  v_mfma_f32_16x16x32_bf16 v[44:47], v[192:195], a[140:143], v[44:47]
  s_waitcnt vmcnt(14)
  v_mfma_f32_16x16x32_bf16 v[32:35], v[196:199], a[144:147], v[32:35]
  s_add_u32 m0, s89, 32768
  s_mov_b32 s90, 294912
  buffer_load_dwordx4 v7, s[40:43], s90 offen lds
  v_mfma_f32_16x16x32_bf16 v[36:39], v[196:199], a[148:151], v[36:39]
  v_mfma_f32_16x16x32_bf16 v[40:43], v[196:199], a[152:155], v[40:43]
  v_mfma_f32_16x16x32_bf16 v[44:47], v[196:199], a[156:159], v[44:47]
  v_mfma_f32_16x16x16_bf16 v[48:51], v[116:117], v[76:77], v[48:51]
  s_waitcnt vmcnt(14)
  v_mfma_f32_16x16x32_bf16 v[32:35], v[200:203], a[160:163], v[32:35]
  s_add_u32 m0, s89, 36864
  s_mov_b32 s90, 344064
  buffer_load_dwordx4 v7, s[40:43], s90 offen lds
  v_mfma_f32_16x16x32_bf16 v[36:39], v[200:203], a[164:167], v[36:39]
  v_mfma_f32_16x16x32_bf16 v[40:43], v[200:203], a[168:171], v[40:43]
  v_mfma_f32_16x16x32_bf16 v[44:47], v[200:203], a[172:175], v[44:47]
  s_waitcnt vmcnt(14)
  v_mfma_f32_16x16x32_bf16 v[32:35], v[204:207], a[176:179], v[32:35]
  s_add_u32 m0, s89, 40960
  s_mov_b32 s90, 376832
  buffer_load_dwordx4 v7, s[40:43], s90 offen lds
  v_mfma_f32_16x16x32_bf16 v[36:39], v[204:207], a[180:183], v[36:39]
  v_mfma_f32_16x16x32_bf16 v[40:43], v[204:207], a[184:187], v[40:43]
  v_mfma_f32_16x16x32_bf16 v[44:47], v[204:207], a[188:191], v[44:47]
  s_waitcnt vmcnt(14)
  v_mfma_f32_16x16x32_bf16 v[32:35], v[208:211], a[192:195], v[32:35]
  s_add_u32 m0, s89, 45056
  s_mov_b32 s90, 409600
  buffer_load_dwordx4 v7, s[40:43], s90 offen lds
  v_mfma_f32_16x16x32_bf16 v[36:39], v[208:211], a[196:199], v[36:39]
  v_mul_f32 v80, v80, v48
  v_mul_f32 v81, v81, v49
  v_mfma_f32_16x16x32_bf16 v[40:43], v[208:211], a[200:203], v[40:43]
  v_mul_f32 v82, v82, v50
  v_mul_f32 v83, v83, v51
  v_mfma_f32_16x16x32_bf16 v[44:47], v[208:211], a[204:207], v[44:47]
  s_waitcnt vmcnt(14)
  v_mfma_f32_16x16x32_bf16 v[32:35], v[212:215], a[208:211], v[32:35]
  s_add_u32 m0, s89, 49152
  s_mov_b32 s90, 458752
  buffer_load_dwordx4 v7, s[40:43], s90 offen lds
  v_mfma_f32_16x16x32_bf16 v[36:39], v[212:215], a[212:215], v[36:39]
  v_cvt_pk_bf16_f32 v86, v80, v81
  v_cvt_pk_bf16_f32 v87, v82, v83
  v_mfma_f32_16x16x32_bf16 v[40:43], v[212:215], a[216:219], v[40:43]
  v_mfma_f32_16x16x32_bf16 v[44:47], v[212:215], a[220:223], v[44:47]
  s_waitcnt vmcnt(14)
  v_mfma_f32_16x16x32_bf16 v[32:35], v[216:219], a[224:227], v[32:35]
  s_add_u32 m0, s89, 53248
  s_mov_b32 s90, 491520
  buffer_load_dwordx4 v7, s[40:43], s90 offen lds
  v_mfma_f32_16x16x32_bf16 v[36:39], v[216:219], a[228:231], v[36:39]
  v_permlane16_swap_b32 v84, v86
  v_permlane16_swap_b32 v85, v87
  v_mfma_f32_16x16x32_bf16 v[40:43], v[216:219], a[232:235], v[40:43]
  buffer_store_dwordx4 v[84:87], v28, s[60:63], 0 offen offset:2048 sc1
  v_mfma_f32_16x16x32_bf16 v[44:47], v[216:219], a[236:239], v[44:47]
  s_waitcnt vmcnt(15)
  v_mfma_f32_16x16x32_bf16 v[32:35], v[220:223], a[240:243], v[32:35]
  s_add_u32 m0, s89, 57344
  s_mov_b32 s90, 524288
  buffer_load_dwordx4 v7, s[40:43], s90 offen lds
  v_mfma_f32_16x16x32_bf16 v[36:39], v[220:223], a[244:247], v[36:39]
  v_mfma_f32_16x16x32_bf16 v[40:43], v[220:223], a[248:251], v[40:43]
  v_mfma_f32_16x16x32_bf16 v[44:47], v[220:223], a[252:255], v[44:47]
  s_add_u32 m0, s89, 61440
  s_mov_b32 s90, 573440
  buffer_load_dwordx4 v7, s[40:43], s90 offen lds
  s_nop 2
  v_cvt_pk_bf16_f32 v64, v36, v37
  v_cvt_pk_bf16_f32 v65, v38, v39
  v_cvt_pk_bf16_f32 v66, v40, v41
  v_cvt_pk_bf16_f32 v67, v42, v43
  v_cvt_pk_bf16_f32 v68, v44, v45
  v_cvt_pk_bf16_f32 v69, v46, v47
  ds_write_b64 v17, v[64:65] offset:0
  ds_write_b64 v18, v[66:67] offset:0
  ds_write_b64 v19, v[68:69] offset:0
  ds_read_b64 v[78:79], v21 offset:3072
  s_waitcnt lgkmcnt(0)
  s_barrier
  ds_read_b64 v[72:73], v20 offset:0
  ds_read_b64 v[74:75], v20 offset:512
  ds_read_b64 v[76:77], v20 offset:1024
  v_lshlrev_b32 v80, 16, v78
  v_and_b32 v81, s69, v78
  v_lshlrev_b32 v82, 16, v79
  v_and_b32 v83, s69, v79
  s_waitcnt lgkmcnt(0)
  v_mfma_f32_16x16x32_bf16 v[32:35], v[116:119], v[72:75], v[32:35]
  s_nop 5
  v_mfma_f32_16x16x16_bf16 v[32:35], v[116:117], v[76:77], v[32:35]
  s_nop 7
  v_mul_f32 v80, v80, v32
  v_mul_f32 v81, v81, v33
  v_mul_f32 v82, v82, v34
  v_mul_f32 v83, v83, v35
  v_cvt_pk_bf16_f32 v88, v80, v81
  v_cvt_pk_bf16_f32 v89, v82, v83
  v_mov_b32 v90, v88
  v_mov_b32 v91, v89
  s_nop 0
  v_permlane16_swap_b32 v88, v90
  v_permlane16_swap_b32 v89, v91
  s_mov_b32 exec_lo, 0xffff
  s_mov_b32 exec_hi, 0xffff
  buffer_store_dwordx4 v[88:91], v27, s[60:63], 0 offen sc1
  s_mov_b64 exec, -1
  s_lshl_b32 s70, s67, 2
  s_add_u32 s70, s70, s66
  s_mul_i32 s70, s70, 28672
  s_add_u32 s70, s70, 13631488
  v_add_u32 v24, s70, v4
  v_lshrrev_b32 v25, 2, v2
  v_lshl_add_u32 v25, v3, 3, v25
  v_lshlrev_b32 v25, 7, v25
  v_and_b32 v26, 3, v2
  v_lshl_add_u32 v25, v26, 3, v25
  v_lshrrev_b32 v26, 3, v2
  v_and_b32 v27, 1, v3
  v_lshl_or_b32 v26, v27, 1, v26
  v_xor_b32 v27, 0, v26
  v_lshl_add_u32 v16, v27, 5, v25
  v_xor_b32 v27, 1, v26
  v_lshl_add_u32 v17, v27, 5, v25
  v_xor_b32 v27, 2, v26
  v_lshl_add_u32 v18, v27, 5, v25
  v_xor_b32 v27, 3, v26
  v_lshl_add_u32 v19, v27, 5, v25
  v_add_u32 v28, 0x10000, v16
  v_add_u32 v29, 0x10000, v17
  v_add_u32 v30, 0x10000, v18
  v_add_u32 v31, 0x10000, v19
  s_lshl_b32 s70, s67, 16
  s_lshl_b32 s71, s66, 14
  s_add_u32 s70, s70, s71
  s_lshl_b32 s71, s68, 7
  s_add_u32 s70, s70, s71
  v_lshrrev_b32 v21, 3, v1
  v_and_b32 v27, 7, v1
  v_lshlrev_b32 v27, 4, v27
  v_lshl_add_u32 v20, v21, 10, v27
  v_add_u32 v20, s70, v20
  s_mul_i32 s70, s66, 2304
  s_add_u32 s70, s70, 131072
  v_mul_u32_u24 v21, 144, v21
  v_add3_u32 v21, v21, v27, s70
  v_mul_u32_u24 v27, 144, v2
  v_lshl_add_u32 v27, v3, 3, v27
  v_add_u32 v27, s70, v27
  s_mov_b32 s71, 8192
  v_lshlrev_b32 v176, 16, v240
  v_and_b32 v177, s69, v240
  v_lshlrev_b32 v178, 16, v241
  v_and_b32 v179, s69, v241
  v_lshlrev_b32 v180, 16, v242
  v_and_b32 v181, s69, v242
  v_lshlrev_b32 v182, 16, v243
  v_and_b32 v183, s69, v243
  v_lshlrev_b32 v184, 16, v244
  v_and_b32 v185, s69, v244
  v_lshlrev_b32 v186, 16, v245
  v_and_b32 v187, s69, v245
  v_lshlrev_b32 v188, 16, v246
  v_and_b32 v189, s69, v246
  v_lshlrev_b32 v190, 16, v247
  v_and_b32 v191, s69, v247
  s_cmp_eq_u32 s66, 1
  s_cbranch_scc0 L_ow_32
  v_add_u32 v6, 128, v22
  s_mov_b32 s77, 0
  s_mov_b64 exec, 0x1
L_poll_33:
  buffer_load_dword v7, v6, s[60:63], 0 offen  sc1
  s_waitcnt vmcnt(0)
  v_cmp_gt_u32 vcc, 8, v7
  s_nop 0
  s_cbranch_vccz L_polld_34
  s_sleep 1
  s_add_u32 s77, s77, 1
  s_cmp_lt_u32 s77, 200000
  s_cbranch_scc1 L_poll_33
L_polld_34:
  s_mov_b64 exec, -1
L_ow_32:
  s_waitcnt vmcnt(0)
  s_barrier
  s_cmp_eq_u32 s66, 0
  s_cbranch_scc0 L_ow_36
  s_mov_b64 exec, 1
  buffer_atomic_add v23, v22, s[60:63], 0 offen sc1
  s_mov_b64 exec, -1
L_ow_36:
  s_mov_b32 s72, 0
  buffer_load_dwordx4 v[64:67], v24, s[60:63], s72 offen offset:0 sc1
  s_mov_b32 s72, 0
  buffer_load_dwordx4 v[68:71], v24, s[60:63], s72 offen offset:1024 sc1
  s_mov_b32 s72, 0
  buffer_load_dwordx4 v[72:75], v24, s[60:63], s72 offen offset:3072 sc1
  s_mov_b32 s72, 4096
  buffer_load_dwordx4 v[76:79], v24, s[60:63], s72 offen offset:0 sc1
  s_mov_b32 s72, 4096
  buffer_load_dwordx4 v[80:83], v24, s[60:63], s72 offen offset:2048 sc1
  s_mov_b32 s72, 4096
  buffer_load_dwordx4 v[84:87], v24, s[60:63], s72 offen offset:3072 sc1
  s_mov_b32 s72, 8192
  buffer_load_dwordx4 v[88:91], v24, s[60:63], s72 offen offset:1024 sc1
  s_mov_b32 s72, 8192
  buffer_load_dwordx4 v[92:95], v24, s[60:63], s72 offen offset:2048 sc1
  s_mov_b32 s72, 12288
  buffer_load_dwordx4 v[96:99], v24, s[60:63], s72 offen offset:0 sc1
  s_mov_b32 s72, 12288
  buffer_load_dwordx4 v[100:103], v24, s[60:63], s72 offen offset:1024 sc1
  s_mov_b32 s72, 12288
  buffer_load_dwordx4 v[104:107], v24, s[60:63], s72 offen offset:3072 sc1
  s_mov_b32 s72, 16384
  buffer_load_dwordx4 v[108:111], v24, s[60:63], s72 offen offset:0 sc1
  s_mov_b32 s72, 16384
  buffer_load_dwordx4 v[112:115], v24, s[60:63], s72 offen offset:2048 sc1
  s_mov_b32 s72, 16384
  buffer_load_dwordx4 v[116:119], v24, s[60:63], s72 offen offset:3072 sc1
  s_mov_b32 s72, 20480
  buffer_load_dwordx4 v[120:123], v24, s[60:63], s72 offen offset:1024 sc1
  s_mov_b32 s72, 20480
  buffer_load_dwordx4 v[124:127], v24, s[60:63], s72 offen offset:2048 sc1
  ds_read_b64_tr_b16 v[192:193], v16 offset:0
  ds_read_b64_tr_b16 v[194:195], v16 offset:512
  ds_read_b64_tr_b16 v[196:197], v17 offset:0
  ds_read_b64_tr_b16 v[198:199], v17 offset:512
  ds_read_b64_tr_b16 v[200:201], v18 offset:0
  ds_read_b64_tr_b16 v[202:203], v18 offset:512
  ds_read_b64_tr_b16 v[204:205], v19 offset:0
  ds_read_b64_tr_b16 v[206:207], v19 offset:512
  ds_read_b64_tr_b16 v[208:209], v16 offset:4096
  ds_read_b64_tr_b16 v[210:211], v16 offset:4608
  ds_read_b64_tr_b16 v[212:213], v17 offset:4096
  ds_read_b64_tr_b16 v[214:215], v17 offset:4608
  ds_read_b64_tr_b16 v[216:217], v18 offset:4096
  ds_read_b64_tr_b16 v[218:219], v18 offset:4608
  ds_read_b64_tr_b16 v[220:221], v19 offset:4096
  ds_read_b64_tr_b16 v[222:223], v19 offset:4608
  s_waitcnt lgkmcnt(8)
  s_waitcnt vmcnt(15)
  v_mfma_f32_16x16x32_bf16 v[32:35], v[192:195], v[64:67], 0
  ds_read_b64_tr_b16 v[48:49], v16 offset:12288
  ds_read_b64_tr_b16 v[50:51], v16 offset:12800
  v_mfma_f32_16x16x32_bf16 v[36:39], v[196:199], v[64:67], 0
  ds_read_b64_tr_b16 v[52:53], v17 offset:12288
  ds_read_b64_tr_b16 v[54:55], v17 offset:12800
  v_mfma_f32_16x16x32_bf16 v[40:43], v[200:203], v[64:67], 0
  ds_read_b64_tr_b16 v[56:57], v18 offset:12288
  ds_read_b64_tr_b16 v[58:59], v18 offset:12800
  v_mfma_f32_16x16x32_bf16 v[44:47], v[204:207], v[64:67], 0
  ds_read_b64_tr_b16 v[60:61], v19 offset:12288
  ds_read_b64_tr_b16 v[62:63], v19 offset:12800
  s_waitcnt lgkmcnt(8)
  s_waitcnt vmcnt(14)
  v_mfma_f32_16x16x32_bf16 v[32:35], v[208:211], v[68:71], v[32:35]
  ds_read_b64_tr_b16 v[192:193], v16 offset:16384
  ds_read_b64_tr_b16 v[194:195], v16 offset:16896
  v_mfma_f32_16x16x32_bf16 v[36:39], v[212:215], v[68:71], v[36:39]
  ds_read_b64_tr_b16 v[196:197], v17 offset:16384
  ds_read_b64_tr_b16 v[198:199], v17 offset:16896
  v_mfma_f32_16x16x32_bf16 v[40:43], v[216:219], v[68:71], v[40:43]
  ds_read_b64_tr_b16 v[200:201], v18 offset:16384
  ds_read_b64_tr_b16 v[202:203], v18 offset:16896
  v_mfma_f32_16x16x32_bf16 v[44:47], v[220:223], v[68:71], v[44:47]
  ds_read_b64_tr_b16 v[204:205], v19 offset:16384
  ds_read_b64_tr_b16 v[206:207], v19 offset:16896
  s_waitcnt lgkmcnt(8)
  s_waitcnt vmcnt(13)
  v_mfma_f32_16x16x32_bf16 v[32:35], v[48:51], v[72:75], v[32:35]
  ds_read_b64_tr_b16 v[208:209], v16 offset:24576
  ds_read_b64_tr_b16 v[210:211], v16 offset:25088
  v_mfma_f32_16x16x32_bf16 v[36:39], v[52:55], v[72:75], v[36:39]
  ds_read_b64_tr_b16 v[212:213], v17 offset:24576
  ds_read_b64_tr_b16 v[214:215], v17 offset:25088
  v_mfma_f32_16x16x32_bf16 v[40:43], v[56:59], v[72:75], v[40:43]
  ds_read_b64_tr_b16 v[216:217], v18 offset:24576
  ds_read_b64_tr_b16 v[218:219], v18 offset:25088
  v_mfma_f32_16x16x32_bf16 v[44:47], v[60:63], v[72:75], v[44:47]
  ds_read_b64_tr_b16 v[220:221], v19 offset:24576
  ds_read_b64_tr_b16 v[222:223], v19 offset:25088
  s_waitcnt lgkmcnt(8)
  s_waitcnt vmcnt(12)
  v_mfma_f32_16x16x32_bf16 v[32:35], v[192:195], v[76:79], v[32:35]
  ds_read_b64_tr_b16 v[48:49], v16 offset:28672
  ds_read_b64_tr_b16 v[50:51], v16 offset:29184
  v_mfma_f32_16x16x32_bf16 v[36:39], v[196:199], v[76:79], v[36:39]
  ds_read_b64_tr_b16 v[52:53], v17 offset:28672
  ds_read_b64_tr_b16 v[54:55], v17 offset:29184
  v_mfma_f32_16x16x32_bf16 v[40:43], v[200:203], v[76:79], v[40:43]
  ds_read_b64_tr_b16 v[56:57], v18 offset:28672
  ds_read_b64_tr_b16 v[58:59], v18 offset:29184
  v_mfma_f32_16x16x32_bf16 v[44:47], v[204:207], v[76:79], v[44:47]
  ds_read_b64_tr_b16 v[60:61], v19 offset:28672
  ds_read_b64_tr_b16 v[62:63], v19 offset:29184
  s_cmp_eq_u32 s66, 0
  s_cbranch_scc0 L_ow_37
  s_mov_b32 s77, 0
  s_mov_b64 exec, 0x1
L_poll_38:
  buffer_load_dword v23, v22, s[60:63], 0 offen  sc1
  s_waitcnt vmcnt(0)
  v_cmp_gt_u32 vcc, 8, v23
  s_nop 0
  s_cbranch_vccz L_polld_39
  s_sleep 1
  s_add_u32 s77, s77, 1
  s_cmp_lt_u32 s77, 200000
  s_cbranch_scc1 L_poll_38
L_polld_39:
  s_mov_b64 exec, -1
L_ow_37:
  s_barrier
  s_mov_b32 s72, 0
  buffer_load_dwordx4 v[128:131], v24, s[60:63], s72 offen offset:2048 sc1
  s_mov_b32 s72, 4096
  buffer_load_dwordx4 v[132:135], v24, s[60:63], s72 offen offset:1024 sc1
  s_mov_b32 s72, 8192
  buffer_load_dwordx4 v[136:139], v24, s[60:63], s72 offen offset:0 sc1
  s_mov_b32 s72, 8192
  buffer_load_dwordx4 v[140:143], v24, s[60:63], s72 offen offset:3072 sc1
  s_mov_b32 s72, 12288
  buffer_load_dwordx4 v[144:147], v24, s[60:63], s72 offen offset:2048 sc1
  s_mov_b32 s72, 16384
  buffer_load_dwordx4 v[148:151], v24, s[60:63], s72 offen offset:1024 sc1
  s_mov_b32 s72, 20480
  buffer_load_dwordx4 v[152:155], v24, s[60:63], s72 offen offset:0 sc1
  s_mov_b32 s72, 20480
  buffer_load_dwordx4 v[156:159], v24, s[60:63], s72 offen offset:3072 sc1
  s_mov_b32 s72, 24576
  buffer_load_dwordx4 v[160:163], v24, s[60:63], s72 offen offset:0 sc1
  s_mov_b32 s72, 24576
  buffer_load_dwordx4 v[164:167], v24, s[60:63], s72 offen offset:1024 sc1
  s_mov_b32 s72, 24576
  buffer_load_dwordx4 v[168:171], v24, s[60:63], s72 offen offset:2048 sc1
  s_mov_b32 s72, 24576
  buffer_load_dwordx4 v[172:175], v24, s[60:63], s72 offen offset:3072 sc1
  s_waitcnt lgkmcnt(8)
  s_waitcnt vmcnt(23)
  v_mfma_f32_16x16x32_bf16 v[32:35], v[208:211], v[80:83], v[32:35]
  ds_read_b64_tr_b16 v[192:193], v16 offset:36864
  ds_read_b64_tr_b16 v[194:195], v16 offset:37376
  v_mfma_f32_16x16x32_bf16 v[36:39], v[212:215], v[80:83], v[36:39]
  ds_read_b64_tr_b16 v[196:197], v17 offset:36864
  ds_read_b64_tr_b16 v[198:199], v17 offset:37376
  v_mfma_f32_16x16x32_bf16 v[40:43], v[216:219], v[80:83], v[40:43]
  ds_read_b64_tr_b16 v[200:201], v18 offset:36864
  ds_read_b64_tr_b16 v[202:203], v18 offset:37376
  v_mfma_f32_16x16x32_bf16 v[44:47], v[220:223], v[80:83], v[44:47]
  ds_read_b64_tr_b16 v[204:205], v19 offset:36864
  ds_read_b64_tr_b16 v[206:207], v19 offset:37376
  s_waitcnt lgkmcnt(8)
  s_waitcnt vmcnt(22)
  v_mfma_f32_16x16x32_bf16 v[32:35], v[48:51], v[84:87], v[32:35]
  ds_read_b64_tr_b16 v[208:209], v16 offset:40960
  ds_read_b64_tr_b16 v[210:211], v16 offset:41472
  v_mfma_f32_16x16x32_bf16 v[36:39], v[52:55], v[84:87], v[36:39]
  ds_read_b64_tr_b16 v[212:213], v17 offset:40960
  ds_read_b64_tr_b16 v[214:215], v17 offset:41472
  v_mfma_f32_16x16x32_bf16 v[40:43], v[56:59], v[84:87], v[40:43]
  ds_read_b64_tr_b16 v[216:217], v18 offset:40960
  ds_read_b64_tr_b16 v[218:219], v18 offset:41472
  v_mfma_f32_16x16x32_bf16 v[44:47], v[60:63], v[84:87], v[44:47]
  ds_read_b64_tr_b16 v[220:221], v19 offset:40960
  ds_read_b64_tr_b16 v[222:223], v19 offset:41472
  s_waitcnt lgkmcnt(8)
  s_waitcnt vmcnt(21)
  v_mfma_f32_16x16x32_bf16 v[32:35], v[192:195], v[88:91], v[32:35]
  ds_read_b64_tr_b16 v[48:49], v16 offset:49152
  ds_read_b64_tr_b16 v[50:51], v16 offset:49664
  v_mfma_f32_16x16x32_bf16 v[36:39], v[196:199], v[88:91], v[36:39]
  ds_read_b64_tr_b16 v[52:53], v17 offset:49152
  ds_read_b64_tr_b16 v[54:55], v17 offset:49664
  v_mfma_f32_16x16x32_bf16 v[40:43], v[200:203], v[88:91], v[40:43]
  ds_read_b64_tr_b16 v[56:57], v18 offset:49152
  ds_read_b64_tr_b16 v[58:59], v18 offset:49664
  v_mfma_f32_16x16x32_bf16 v[44:47], v[204:207], v[88:91], v[44:47]
  ds_read_b64_tr_b16 v[60:61], v19 offset:49152
  ds_read_b64_tr_b16 v[62:63], v19 offset:49664
  s_waitcnt lgkmcnt(8)
  s_waitcnt vmcnt(20)
  v_mfma_f32_16x16x32_bf16 v[32:35], v[208:211], v[92:95], v[32:35]
  ds_read_b64_tr_b16 v[192:193], v16 offset:53248
  ds_read_b64_tr_b16 v[194:195], v16 offset:53760
  v_mfma_f32_16x16x32_bf16 v[36:39], v[212:215], v[92:95], v[36:39]
  ds_read_b64_tr_b16 v[196:197], v17 offset:53248
  ds_read_b64_tr_b16 v[198:199], v17 offset:53760
  v_mfma_f32_16x16x32_bf16 v[40:43], v[216:219], v[92:95], v[40:43]
  ds_read_b64_tr_b16 v[200:201], v18 offset:53248
  ds_read_b64_tr_b16 v[202:203], v18 offset:53760
  v_mfma_f32_16x16x32_bf16 v[44:47], v[220:223], v[92:95], v[44:47]
  ds_read_b64_tr_b16 v[204:205], v19 offset:53248
  ds_read_b64_tr_b16 v[206:207], v19 offset:53760
  s_waitcnt lgkmcnt(8)
  s_waitcnt vmcnt(19)
  v_mfma_f32_16x16x32_bf16 v[32:35], v[48:51], v[96:99], v[32:35]
  ds_read_b64_tr_b16 v[208:209], v16 offset:61440
  ds_read_b64_tr_b16 v[210:211], v16 offset:61952
  v_mfma_f32_16x16x32_bf16 v[36:39], v[52:55], v[96:99], v[36:39]
  ds_read_b64_tr_b16 v[212:213], v17 offset:61440
  ds_read_b64_tr_b16 v[214:215], v17 offset:61952
  v_mfma_f32_16x16x32_bf16 v[40:43], v[56:59], v[96:99], v[40:43]
  ds_read_b64_tr_b16 v[216:217], v18 offset:61440
  ds_read_b64_tr_b16 v[218:219], v18 offset:61952
  v_mfma_f32_16x16x32_bf16 v[44:47], v[60:63], v[96:99], v[44:47]
  ds_read_b64_tr_b16 v[220:221], v19 offset:61440
  ds_read_b64_tr_b16 v[222:223], v19 offset:61952
  s_waitcnt lgkmcnt(8)
  s_waitcnt vmcnt(18)
  v_mfma_f32_16x16x32_bf16 v[32:35], v[192:195], v[100:103], v[32:35]
  ds_read_b64_tr_b16 v[48:49], v28 offset:0
  ds_read_b64_tr_b16 v[50:51], v28 offset:512
  v_mfma_f32_16x16x32_bf16 v[36:39], v[196:199], v[100:103], v[36:39]
  ds_read_b64_tr_b16 v[52:53], v29 offset:0
  ds_read_b64_tr_b16 v[54:55], v29 offset:512
  v_mfma_f32_16x16x32_bf16 v[40:43], v[200:203], v[100:103], v[40:43]
  ds_read_b64_tr_b16 v[56:57], v30 offset:0
  ds_read_b64_tr_b16 v[58:59], v30 offset:512
  v_mfma_f32_16x16x32_bf16 v[44:47], v[204:207], v[100:103], v[44:47]
  ds_read_b64_tr_b16 v[60:61], v31 offset:0
  ds_read_b64_tr_b16 v[62:63], v31 offset:512
  s_waitcnt lgkmcnt(8)
  s_waitcnt vmcnt(17)
  v_mfma_f32_16x16x32_bf16 v[32:35], v[208:211], v[104:107], v[32:35]
  ds_read_b64_tr_b16 v[192:193], v28 offset:8192
  ds_read_b64_tr_b16 v[194:195], v28 offset:8704
  v_mfma_f32_16x16x32_bf16 v[36:39], v[212:215], v[104:107], v[36:39]
  ds_read_b64_tr_b16 v[196:197], v29 offset:8192
  ds_read_b64_tr_b16 v[198:199], v29 offset:8704
  v_mfma_f32_16x16x32_bf16 v[40:43], v[216:219], v[104:107], v[40:43]
  ds_read_b64_tr_b16 v[200:201], v30 offset:8192
  ds_read_b64_tr_b16 v[202:203], v30 offset:8704
  v_mfma_f32_16x16x32_bf16 v[44:47], v[220:223], v[104:107], v[44:47]
  ds_read_b64_tr_b16 v[204:205], v31 offset:8192
  ds_read_b64_tr_b16 v[206:207], v31 offset:8704
  s_waitcnt lgkmcnt(8)
  s_waitcnt vmcnt(16)
  v_mfma_f32_16x16x32_bf16 v[32:35], v[48:51], v[108:111], v[32:35]
  ds_read_b64_tr_b16 v[208:209], v28 offset:12288
  ds_read_b64_tr_b16 v[210:211], v28 offset:12800
  v_mfma_f32_16x16x32_bf16 v[36:39], v[52:55], v[108:111], v[36:39]
  ds_read_b64_tr_b16 v[212:213], v29 offset:12288
  ds_read_b64_tr_b16 v[214:215], v29 offset:12800
  v_mfma_f32_16x16x32_bf16 v[40:43], v[56:59], v[108:111], v[40:43]
  ds_read_b64_tr_b16 v[216:217], v30 offset:12288
  ds_read_b64_tr_b16 v[218:219], v30 offset:12800
  v_mfma_f32_16x16x32_bf16 v[44:47], v[60:63], v[108:111], v[44:47]
  ds_read_b64_tr_b16 v[220:221], v31 offset:12288
  ds_read_b64_tr_b16 v[222:223], v31 offset:12800
  s_waitcnt lgkmcnt(8)
  s_waitcnt vmcnt(15)
  v_mfma_f32_16x16x32_bf16 v[32:35], v[192:195], v[112:115], v[32:35]
  ds_read_b64_tr_b16 v[48:49], v28 offset:20480
  ds_read_b64_tr_b16 v[50:51], v28 offset:20992
  v_mfma_f32_16x16x32_bf16 v[36:39], v[196:199], v[112:115], v[36:39]
  ds_read_b64_tr_b16 v[52:53], v29 offset:20480
  ds_read_b64_tr_b16 v[54:55], v29 offset:20992
  v_mfma_f32_16x16x32_bf16 v[40:43], v[200:203], v[112:115], v[40:43]
  ds_read_b64_tr_b16 v[56:57], v30 offset:20480
  ds_read_b64_tr_b16 v[58:59], v30 offset:20992
  v_mfma_f32_16x16x32_bf16 v[44:47], v[204:207], v[112:115], v[44:47]
  ds_read_b64_tr_b16 v[60:61], v31 offset:20480
  ds_read_b64_tr_b16 v[62:63], v31 offset:20992
  s_waitcnt lgkmcnt(8)
  s_waitcnt vmcnt(14)
  v_mfma_f32_16x16x32_bf16 v[32:35], v[208:211], v[116:119], v[32:35]
  ds_read_b64_tr_b16 v[192:193], v28 offset:24576
  ds_read_b64_tr_b16 v[194:195], v28 offset:25088
  v_mfma_f32_16x16x32_bf16 v[36:39], v[212:215], v[116:119], v[36:39]
  ds_read_b64_tr_b16 v[196:197], v29 offset:24576
  ds_read_b64_tr_b16 v[198:199], v29 offset:25088
  v_mfma_f32_16x16x32_bf16 v[40:43], v[216:219], v[116:119], v[40:43]
  ds_read_b64_tr_b16 v[200:201], v30 offset:24576
  ds_read_b64_tr_b16 v[202:203], v30 offset:25088
  v_mfma_f32_16x16x32_bf16 v[44:47], v[220:223], v[116:119], v[44:47]
  ds_read_b64_tr_b16 v[204:205], v31 offset:24576
  ds_read_b64_tr_b16 v[206:207], v31 offset:25088
  s_waitcnt lgkmcnt(8)
  s_waitcnt vmcnt(13)
  v_mfma_f32_16x16x32_bf16 v[32:35], v[48:51], v[120:123], v[32:35]
  ds_read_b64_tr_b16 v[208:209], v16 offset:8192
  ds_read_b64_tr_b16 v[210:211], v16 offset:8704
  v_mfma_f32_16x16x32_bf16 v[36:39], v[52:55], v[120:123], v[36:39]
  ds_read_b64_tr_b16 v[212:213], v17 offset:8192
  ds_read_b64_tr_b16 v[214:215], v17 offset:8704
  v_mfma_f32_16x16x32_bf16 v[40:43], v[56:59], v[120:123], v[40:43]
  ds_read_b64_tr_b16 v[216:217], v18 offset:8192
  ds_read_b64_tr_b16 v[218:219], v18 offset:8704
  v_mfma_f32_16x16x32_bf16 v[44:47], v[60:63], v[120:123], v[44:47]
  ds_read_b64_tr_b16 v[220:221], v19 offset:8192
  ds_read_b64_tr_b16 v[222:223], v19 offset:8704
  s_waitcnt lgkmcnt(8)
  s_waitcnt vmcnt(12)
  v_mfma_f32_16x16x32_bf16 v[32:35], v[192:195], v[124:127], v[32:35]
  ds_read_b64_tr_b16 v[48:49], v16 offset:20480
  ds_read_b64_tr_b16 v[50:51], v16 offset:20992
  v_mfma_f32_16x16x32_bf16 v[36:39], v[196:199], v[124:127], v[36:39]
  ds_read_b64_tr_b16 v[52:53], v17 offset:20480
  ds_read_b64_tr_b16 v[54:55], v17 offset:20992
  v_mfma_f32_16x16x32_bf16 v[40:43], v[200:203], v[124:127], v[40:43]
  ds_read_b64_tr_b16 v[56:57], v18 offset:20480
  ds_read_b64_tr_b16 v[58:59], v18 offset:20992
  v_mfma_f32_16x16x32_bf16 v[44:47], v[204:207], v[124:127], v[44:47]
  ds_read_b64_tr_b16 v[60:61], v19 offset:20480
  ds_read_b64_tr_b16 v[62:63], v19 offset:20992
  s_waitcnt lgkmcnt(8)
  s_waitcnt vmcnt(11)
  v_mfma_f32_16x16x32_bf16 v[32:35], v[208:211], v[128:131], v[32:35]
  ds_read_b64_tr_b16 v[192:193], v16 offset:32768
  ds_read_b64_tr_b16 v[194:195], v16 offset:33280
  v_mfma_f32_16x16x32_bf16 v[36:39], v[212:215], v[128:131], v[36:39]
  ds_read_b64_tr_b16 v[196:197], v17 offset:32768
  ds_read_b64_tr_b16 v[198:199], v17 offset:33280
  v_mfma_f32_16x16x32_bf16 v[40:43], v[216:219], v[128:131], v[40:43]
  ds_read_b64_tr_b16 v[200:201], v18 offset:32768
  ds_read_b64_tr_b16 v[202:203], v18 offset:33280
  v_mfma_f32_16x16x32_bf16 v[44:47], v[220:223], v[128:131], v[44:47]
  ds_read_b64_tr_b16 v[204:205], v19 offset:32768
  ds_read_b64_tr_b16 v[206:207], v19 offset:33280
  s_waitcnt lgkmcnt(8)
  s_waitcnt vmcnt(10)
  v_mfma_f32_16x16x32_bf16 v[32:35], v[48:51], v[132:135], v[32:35]
  ds_read_b64_tr_b16 v[208:209], v16 offset:45056
  ds_read_b64_tr_b16 v[210:211], v16 offset:45568
  v_mfma_f32_16x16x32_bf16 v[36:39], v[52:55], v[132:135], v[36:39]
  ds_read_b64_tr_b16 v[212:213], v17 offset:45056
  ds_read_b64_tr_b16 v[214:215], v17 offset:45568
  v_mfma_f32_16x16x32_bf16 v[40:43], v[56:59], v[132:135], v[40:43]
  ds_read_b64_tr_b16 v[216:217], v18 offset:45056
  ds_read_b64_tr_b16 v[218:219], v18 offset:45568
  v_mfma_f32_16x16x32_bf16 v[44:47], v[60:63], v[132:135], v[44:47]
  ds_read_b64_tr_b16 v[220:221], v19 offset:45056
  ds_read_b64_tr_b16 v[222:223], v19 offset:45568
  s_waitcnt lgkmcnt(8)
  s_waitcnt vmcnt(9)
  v_mfma_f32_16x16x32_bf16 v[32:35], v[192:195], v[136:139], v[32:35]
  ds_read_b64_tr_b16 v[48:49], v16 offset:57344
  ds_read_b64_tr_b16 v[50:51], v16 offset:57856
  v_mfma_f32_16x16x32_bf16 v[36:39], v[196:199], v[136:139], v[36:39]
  ds_read_b64_tr_b16 v[52:53], v17 offset:57344
  ds_read_b64_tr_b16 v[54:55], v17 offset:57856
  v_mfma_f32_16x16x32_bf16 v[40:43], v[200:203], v[136:139], v[40:43]
  ds_read_b64_tr_b16 v[56:57], v18 offset:57344
  ds_read_b64_tr_b16 v[58:59], v18 offset:57856
  v_mfma_f32_16x16x32_bf16 v[44:47], v[204:207], v[136:139], v[44:47]
  ds_read_b64_tr_b16 v[60:61], v19 offset:57344
  ds_read_b64_tr_b16 v[62:63], v19 offset:57856
  s_waitcnt lgkmcnt(8)
  s_waitcnt vmcnt(8)
  v_mfma_f32_16x16x32_bf16 v[32:35], v[208:211], v[140:143], v[32:35]
  ds_read_b64_tr_b16 v[192:193], v28 offset:4096
  ds_read_b64_tr_b16 v[194:195], v28 offset:4608
  v_mfma_f32_16x16x32_bf16 v[36:39], v[212:215], v[140:143], v[36:39]
  ds_read_b64_tr_b16 v[196:197], v29 offset:4096
  ds_read_b64_tr_b16 v[198:199], v29 offset:4608
  v_mfma_f32_16x16x32_bf16 v[40:43], v[216:219], v[140:143], v[40:43]
  ds_read_b64_tr_b16 v[200:201], v30 offset:4096
  ds_read_b64_tr_b16 v[202:203], v30 offset:4608
  v_mfma_f32_16x16x32_bf16 v[44:47], v[220:223], v[140:143], v[44:47]
  ds_read_b64_tr_b16 v[204:205], v31 offset:4096
  ds_read_b64_tr_b16 v[206:207], v31 offset:4608
  s_waitcnt lgkmcnt(8)
  s_waitcnt vmcnt(7)
  v_mfma_f32_16x16x32_bf16 v[32:35], v[48:51], v[144:147], v[32:35]
  ds_read_b64_tr_b16 v[208:209], v28 offset:16384
  ds_read_b64_tr_b16 v[210:211], v28 offset:16896
  v_mfma_f32_16x16x32_bf16 v[36:39], v[52:55], v[144:147], v[36:39]
  ds_read_b64_tr_b16 v[212:213], v29 offset:16384
  ds_read_b64_tr_b16 v[214:215], v29 offset:16896
  v_mfma_f32_16x16x32_bf16 v[40:43], v[56:59], v[144:147], v[40:43]
  ds_read_b64_tr_b16 v[216:217], v30 offset:16384
  ds_read_b64_tr_b16 v[218:219], v30 offset:16896
  v_mfma_f32_16x16x32_bf16 v[44:47], v[60:63], v[144:147], v[44:47]
  ds_read_b64_tr_b16 v[220:221], v31 offset:16384
  ds_read_b64_tr_b16 v[222:223], v31 offset:16896
  s_waitcnt lgkmcnt(8)
  s_waitcnt vmcnt(6)
  v_mfma_f32_16x16x32_bf16 v[32:35], v[192:195], v[148:151], v[32:35]
  ds_read_b64_tr_b16 v[48:49], v28 offset:28672
  ds_read_b64_tr_b16 v[50:51], v28 offset:29184
  v_mfma_f32_16x16x32_bf16 v[36:39], v[196:199], v[148:151], v[36:39]
  ds_read_b64_tr_b16 v[52:53], v29 offset:28672
  ds_read_b64_tr_b16 v[54:55], v29 offset:29184
  v_mfma_f32_16x16x32_bf16 v[40:43], v[200:203], v[148:151], v[40:43]
  ds_read_b64_tr_b16 v[56:57], v30 offset:28672
  ds_read_b64_tr_b16 v[58:59], v30 offset:29184
  v_mfma_f32_16x16x32_bf16 v[44:47], v[204:207], v[148:151], v[44:47]
  ds_read_b64_tr_b16 v[60:61], v31 offset:28672
  ds_read_b64_tr_b16 v[62:63], v31 offset:29184
  s_waitcnt lgkmcnt(8)
  s_waitcnt vmcnt(5)
  v_mfma_f32_16x16x32_bf16 v[32:35], v[208:211], v[152:155], v[32:35]
  ds_read_b64_tr_b16 v[192:193], v28 offset:32768
  ds_read_b64_tr_b16 v[194:195], v28 offset:33280
  v_mfma_f32_16x16x32_bf16 v[36:39], v[212:215], v[152:155], v[36:39]
  ds_read_b64_tr_b16 v[196:197], v29 offset:32768
  ds_read_b64_tr_b16 v[198:199], v29 offset:33280
  v_mfma_f32_16x16x32_bf16 v[40:43], v[216:219], v[152:155], v[40:43]
  ds_read_b64_tr_b16 v[200:201], v30 offset:32768
  ds_read_b64_tr_b16 v[202:203], v30 offset:33280
  v_mfma_f32_16x16x32_bf16 v[44:47], v[220:223], v[152:155], v[44:47]
  ds_read_b64_tr_b16 v[204:205], v31 offset:32768
  ds_read_b64_tr_b16 v[206:207], v31 offset:33280
  s_waitcnt lgkmcnt(8)
  s_waitcnt vmcnt(4)
  v_mfma_f32_16x16x32_bf16 v[32:35], v[48:51], v[156:159], v[32:35]
  ds_read_b64_tr_b16 v[208:209], v28 offset:36864
  ds_read_b64_tr_b16 v[210:211], v28 offset:37376
  v_mfma_f32_16x16x32_bf16 v[36:39], v[52:55], v[156:159], v[36:39]
  ds_read_b64_tr_b16 v[212:213], v29 offset:36864
  ds_read_b64_tr_b16 v[214:215], v29 offset:37376
  v_mfma_f32_16x16x32_bf16 v[40:43], v[56:59], v[156:159], v[40:43]
  ds_read_b64_tr_b16 v[216:217], v30 offset:36864
  ds_read_b64_tr_b16 v[218:219], v30 offset:37376
  v_mfma_f32_16x16x32_bf16 v[44:47], v[60:63], v[156:159], v[44:47]
  ds_read_b64_tr_b16 v[220:221], v31 offset:36864
  ds_read_b64_tr_b16 v[222:223], v31 offset:37376
  s_waitcnt lgkmcnt(8)
  s_waitcnt vmcnt(3)
  v_mfma_f32_16x16x32_bf16 v[32:35], v[192:195], v[160:163], v[32:35]
  ds_read_b64_tr_b16 v[48:49], v28 offset:40960
  ds_read_b64_tr_b16 v[50:51], v28 offset:41472
  v_mfma_f32_16x16x32_bf16 v[36:39], v[196:199], v[160:163], v[36:39]
  ds_read_b64_tr_b16 v[52:53], v29 offset:40960
  ds_read_b64_tr_b16 v[54:55], v29 offset:41472
  v_mfma_f32_16x16x32_bf16 v[40:43], v[200:203], v[160:163], v[40:43]
  ds_read_b64_tr_b16 v[56:57], v30 offset:40960
  ds_read_b64_tr_b16 v[58:59], v30 offset:41472
  v_mfma_f32_16x16x32_bf16 v[44:47], v[204:207], v[160:163], v[44:47]
  ds_read_b64_tr_b16 v[60:61], v31 offset:40960
  ds_read_b64_tr_b16 v[62:63], v31 offset:41472
  s_waitcnt lgkmcnt(8)
  s_waitcnt vmcnt(2)
  v_mfma_f32_16x16x32_bf16 v[32:35], v[208:211], v[164:167], v[32:35]
  ds_read_b64_tr_b16 v[192:193], v28 offset:45056
  ds_read_b64_tr_b16 v[194:195], v28 offset:45568
  v_mfma_f32_16x16x32_bf16 v[36:39], v[212:215], v[164:167], v[36:39]
  ds_read_b64_tr_b16 v[196:197], v29 offset:45056
  ds_read_b64_tr_b16 v[198:199], v29 offset:45568
  v_mfma_f32_16x16x32_bf16 v[40:43], v[216:219], v[164:167], v[40:43]
  ds_read_b64_tr_b16 v[200:201], v30 offset:45056
  ds_read_b64_tr_b16 v[202:203], v30 offset:45568
  v_mfma_f32_16x16x32_bf16 v[44:47], v[220:223], v[164:167], v[44:47]
  ds_read_b64_tr_b16 v[204:205], v31 offset:45056
  ds_read_b64_tr_b16 v[206:207], v31 offset:45568
  s_waitcnt lgkmcnt(8)
  s_waitcnt vmcnt(1)
  v_mfma_f32_16x16x32_bf16 v[32:35], v[48:51], v[168:171], v[32:35]
  v_mfma_f32_16x16x32_bf16 v[36:39], v[52:55], v[168:171], v[36:39]
  v_mfma_f32_16x16x32_bf16 v[40:43], v[56:59], v[168:171], v[40:43]
  v_mfma_f32_16x16x32_bf16 v[44:47], v[60:63], v[168:171], v[44:47]
  s_waitcnt lgkmcnt(0)
  s_waitcnt vmcnt(0)
  v_mfma_f32_16x16x32_bf16 v[32:35], v[192:195], v[172:175], v[32:35]
  v_mfma_f32_16x16x32_bf16 v[36:39], v[196:199], v[172:175], v[36:39]
  v_mfma_f32_16x16x32_bf16 v[40:43], v[200:203], v[172:175], v[40:43]
  v_mfma_f32_16x16x32_bf16 v[44:47], v[204:207], v[172:175], v[44:47]
  s_nop 4
  v_pk_fma_f32 v[32:33], v[32:33], v[224:225], v[176:177]
  v_pk_fma_f32 v[34:35], v[34:35], v[226:227], v[178:179]
  v_pk_fma_f32 v[36:37], v[36:37], v[228:229], v[180:181]
  v_pk_fma_f32 v[38:39], v[38:39], v[230:231], v[182:183]
  v_pk_fma_f32 v[40:41], v[40:41], v[232:233], v[184:185]
  v_pk_fma_f32 v[42:43], v[42:43], v[234:235], v[186:187]
  v_pk_fma_f32 v[44:45], v[44:45], v[236:237], v[188:189]
  v_pk_fma_f32 v[46:47], v[46:47], v[238:239], v[190:191]
  v_cvt_pk_bf16_f32 v64, v32, v33
  v_cvt_pk_bf16_f32 v65, v34, v35
  v_cvt_pk_bf16_f32 v66, v36, v37
  v_cvt_pk_bf16_f32 v67, v38, v39
  v_cvt_pk_bf16_f32 v68, v40, v41
  v_cvt_pk_bf16_f32 v69, v42, v43
  v_cvt_pk_bf16_f32 v70, v44, v45
  v_cvt_pk_bf16_f32 v71, v46, v47
  ds_write_b64 v27, v[64:65] offset:0
  ds_write_b64 v27, v[66:67] offset:32
  ds_write_b64 v27, v[68:69] offset:64
  ds_write_b64 v27, v[70:71] offset:96
  s_waitcnt lgkmcnt(0)
  ds_read_b128 v[72:75], v21
  ds_read_b128 v[76:79], v21 offset:1152
  s_waitcnt lgkmcnt(1)
  buffer_store_dwordx4 v[72:75], v20, s[52:55], 0 offen
  s_waitcnt lgkmcnt(0)
  buffer_store_dwordx4 v[76:79], v20, s[52:55], s71 offen
  s_endpgm
L_exit:
  s_endpgm
.section .rodata,"a"
.p2align 6
.amdhsa_kernel adaLN_cond__ssm_conv_h3__mixer_gmlp__prompt_kernel
  .amdhsa_next_free_vgpr 512
  .amdhsa_next_free_sgpr 102
  .amdhsa_accum_offset 256
  .amdhsa_group_segment_fixed_size 0
  .amdhsa_kernarg_size 128
  .amdhsa_user_sgpr_count 2
  .amdhsa_user_sgpr_kernarg_segment_ptr 1
  .amdhsa_system_sgpr_workgroup_id_x 1
.end_amdhsa_kernel
```
